```python
import torch

def _softmax(x, axis=-1):
    return torch.softmax(x, dim=axis)
def _gelu(x):
    return torch.nn.functional.gelu(x, approximate="tanh")
def _silu(x):
    return torch.nn.functional.silu(x)
def _sigmoid(x):
    return torch.sigmoid(x)
def _layernorm(x, axis=-1, eps=1e-5):
    m = x.mean(dim=axis, keepdim=True)
    v = x.var(dim=axis, keepdim=True, unbiased=False)
    return (x - m) / torch.sqrt(v + eps)
def _scatter_add(tgt, idx, src, axis=0):
    return tgt.clone().index_add_(axis, idx, src)
def _segment_sum(src, seg, n):
    out = torch.zeros((n,) + src.shape[1:], dtype=src.dtype)
    return out.index_add_(0, seg, src)
def _pad(x, pw):
    flat = tuple(v for pair in reversed(pw) for v in pair)
    return torch.nn.functional.pad(x, flat)

kernel_name = 'parallel_sum__mha_block__dense_activation_mish__prompt'

def setup_inputs():

    _w = (lambda a: (lambda t: t.to(torch.bfloat16) if t.is_floating_point() else t)(torch.as_tensor(a)))
    def _A_setup():
        B, S, D, H = 1, 2048, 512, 32
        return {
            "x": _w((lambda *s: torch.randn(*s, dtype=torch.bfloat16) * 0.05)(B, S, D)),
            "wqkv": _w((lambda *s: torch.randn(*s, dtype=torch.bfloat16) * 0.05)(D, 3 * D)),
            "wo": _w((lambda *s: torch.randn(*s, dtype=torch.bfloat16) * 0.05)(D, D)),
        }
    _A_in = _A_setup()

    def _B_setup():
        B, S, D, F = 1, 2048, 512, 1792
        return {
            "x": _w((lambda *s: torch.randn(*s, dtype=torch.bfloat16) * 0.05)(B, S, D)),
            "w1": _w((lambda *s: torch.randn(*s, dtype=torch.bfloat16) * 0.8)(D, F) * (D ** -0.5)),
            "b1": _w((lambda *s: torch.randn(*s, dtype=torch.bfloat16) * 0.8)(F)),
            "w2": _w((lambda *s: torch.randn(*s, dtype=torch.bfloat16) * 0.2)(F, D) * (F ** -0.5)),
        }
    _B_in = _B_setup()

    return {
        "A_x": _A_in["x"],
        "A_wqkv": _A_in["wqkv"],
        "A_wo": _A_in["wo"],
        "B_x": _B_in["x"],
        "B_w1": _B_in["w1"],
        "B_b1": _B_in["b1"],
        "B_w2": _B_in["w2"],
    }

def reference(A_x, A_wqkv, A_wo, B_x, B_w1, B_b1, B_w2):
    def _A_ref(x, wqkv, wo):
        B, S, D = x.shape
        H = 32
        Dh = D // H
        qkv = (lambda x, *d: x.permute(*d))((x @ wqkv).reshape(B, S, 3, H, Dh), 2, 0, 3, 1, 4)
        q, k, v = qkv[0], qkv[1], qkv[2]
        scores = torch.einsum("bhqd,bhkd->bhqk", q, k) * (Dh ** -0.5)
        p = _softmax(scores, axis=-1)
        o = torch.einsum("bhqk,bhkd->bhqd", p, v)
        return (lambda x, *d: x.permute(*d))(o, 0, 2, 1, 3).reshape(B, S, D) @ wo

    def _B_ref(x, w1, b1, w2):
        h = torch.einsum("bsd,df->bsf", x, w1) + b1
        sp = torch.log1p(torch.exp(-torch.abs(h))) + torch.where(h > 0, h, torch.zeros_like(h))
        act = h * torch.tanh(sp)
        return torch.einsum("bsf,fd->bsd", act, w2)

    x = A_x
    xn = _layernorm(x, axis=-1)
    return x + _A_ref(xn, A_wqkv, A_wo) + _B_ref(xn, B_w1, B_b1, B_w2)
```

```asm
; @launch kernel=k1_kernel grid=(256,1,1) block=(768,1,1) lds=151040
; @launch kernel=k2_kernel grid=(256,1,1) block=(512,1,1) lds=155904
.amdgcn_target "amdgcn-amd-amdhsa--gfx950"
.text
.globl k1_kernel
.p2align 8
.type k1_kernel,@function
k1_kernel:
    s_cmp_ge_u32 s2, 256
    s_cbranch_scc1 k1_end
    s_load_dwordx4 s[36:39], s[0:1], 0
    s_load_dwordx4 s[44:47], s[0:1], 32
    s_load_dwordx2 s[40:41], s[0:1], 16
    s_load_dwordx2 s[48:49], s[0:1], 48
    s_load_dwordx2 s[50:51], s[0:1], 72
    v_lshrrev_b32 v2, 6, v0
    v_and_b32 v1, 63, v0
    v_readfirstlane_b32 s24, v2
    v_lshrrev_b32 v8, 5, v1
    v_and_b32 v9, 31, v1
    s_and_b32 s53, s2, 7
    s_lshr_b32 s54, s2, 3
    s_and_b32 s27, s53, 1
    s_lshl_b32 s27, s27, 3
    s_and_b32 s55, s54, 7
    s_add_u32 s27, s27, s55
    s_lshr_b32 s28, s53, 1
    s_mul_i32 s57, s28, 14
    s_lshl_b32 s28, s28, 2
    s_lshr_b32 s55, s54, 3
    s_add_u32 s28, s28, s55
    s_lshl_b32 s53, s55, 2
    s_add_u32 s57, s57, s53
    s_cmp_eq_u32 s55, 3
    s_cselect_b32 s69, 2, 4
    s_and_b32 s25, s24, 3
    s_lshr_b32 s26, s24, 2
    s_mul_i32 s58, s28, 3
    s_cmp_eq_u32 s26, 2
    s_cbranch_scc1 k1_kernel_prod1
    v_bfe_u32 v2, v9, 1, 3
    v_xor_b32 v2, v2, v8
    v_lshlrev_b32 v2, 4, v2
    v_lshl_add_u32 v4, v9, 7, v2
    v_bfe_u32 v6, v1, 2, 2
    v_lshl_add_u32 v5, v8, 3, v6
    v_lshlrev_b32 v5, 8, v5
    v_bfe_u32 v7, v1, 4, 1
    v_lshl_add_u32 v5, v7, 5, v5
    v_and_b32 v7, 3, v1
    v_lshl_add_u32 v5, v7, 3, v5
    v_add_u32 v5, 49152, v5
    v_mov_b32 v2, 0
    v_mov_b32 v3, 0x3f803f80
    v_cmp_eq_u32 vcc, 0, v9
    v_cmp_eq_u32 s[72:73], 17, v9
    s_nop 1
    s_or_b64 vcc, vcc, s[72:73]
    s_nop 1
    v_cndmask_b32 v24, v2, v3, vcc
    v_mov_b32 v25, v24
    v_mov_b32 v26, v24
    v_mov_b32 v27, v24
    s_mov_b32 s56, 0
    s_mov_b32 s63, 0
    s_lshl_b32 s68, s25, 2
    s_waitcnt lgkmcnt(0)
    s_mov_b32 s12, s50
    s_and_b32 s13, s51, 0xffff
    s_mov_b32 s14, 0x10000000
    s_mov_b32 s15, 0x20000
    s_cmp_eq_u32 s26, 1
    s_cbranch_scc1 k1_kernel_role12
    s_mov_b32 s20, s46
    s_and_b32 s21, s47, 0xffff
    s_mov_b32 s22, 0xe00
    s_mov_b32 s23, 0x20000
    s_lshl_b32 s53, s57, 6
    v_lshlrev_b32 v2, 1, v0
    buffer_load_ushort v21, v2, s[20:23], s53 offen
    s_lshr_b32 s53, s24, 1
    s_and_b32 s54, s24, 1
    s_lshl_b32 s59, s53, 1
    s_or_b32 s59, s59, s54
    s_xor_b32 s42, s59, 1
    s_lshl_b32 s43, s54, 1
    s_or_b32 s43, s43, s53
    s_xor_b32 s52, s43, 1
    s_lshl_b32 s53, s59, 12
    v_add_u32 v10, s53, v4
    v_xor_b32 v11, 32, v10
    v_xor_b32 v12, 64, v10
    v_xor_b32 v13, 96, v10
    s_lshl_b32 s53, s42, 12
    v_add_u32 v14, s53, v4
    v_xor_b32 v15, 32, v14
    v_xor_b32 v16, 64, v14
    v_xor_b32 v17, 96, v14
    v_xor_b32 v7, s43, v6
    v_lshl_add_u32 v18, v7, 6, v5
    v_xor_b32 v7, s52, v6
    v_lshl_add_u32 v19, v7, 6, v5
    v_mov_b32 v32, 0
    v_mov_b32 v33, 0
    v_mov_b32 v34, 0
    v_mov_b32 v35, 0
    v_mov_b32 v36, 0
    v_mov_b32 v37, 0
    v_mov_b32 v38, 0
    v_mov_b32 v39, 0
    v_mov_b32 v40, 0
    v_mov_b32 v41, 0
    v_mov_b32 v42, 0
    v_mov_b32 v43, 0
    v_mov_b32 v44, 0
    v_mov_b32 v45, 0
    v_mov_b32 v46, 0
    v_mov_b32 v47, 0
    v_mov_b32 v48, 0
    v_mov_b32 v49, 0
    v_mov_b32 v50, 0
    v_mov_b32 v51, 0
    v_mov_b32 v52, 0
    v_mov_b32 v53, 0
    v_mov_b32 v54, 0
    v_mov_b32 v55, 0
    v_mov_b32 v56, 0
    v_mov_b32 v57, 0
    v_mov_b32 v58, 0
    v_mov_b32 v59, 0
    v_mov_b32 v60, 0
    v_mov_b32 v61, 0
    v_mov_b32 v62, 0
    v_mov_b32 v63, 0
    v_mov_b32 v64, 0
    v_mov_b32 v65, 0
    v_mov_b32 v66, 0
    v_mov_b32 v67, 0
    v_mov_b32 v68, 0
    v_mov_b32 v69, 0
    v_mov_b32 v70, 0
    v_mov_b32 v71, 0
    v_mov_b32 v72, 0
    v_mov_b32 v73, 0
    v_mov_b32 v74, 0
    v_mov_b32 v75, 0
    v_mov_b32 v76, 0
    v_mov_b32 v77, 0
    v_mov_b32 v78, 0
    v_mov_b32 v79, 0
    v_mov_b32 v80, 0
    v_mov_b32 v81, 0
    v_mov_b32 v82, 0
    v_mov_b32 v83, 0
    v_mov_b32 v84, 0
    v_mov_b32 v85, 0
    v_mov_b32 v86, 0
    v_mov_b32 v87, 0
    v_mov_b32 v88, 0
    v_mov_b32 v89, 0
    v_mov_b32 v90, 0
    v_mov_b32 v91, 0
    v_mov_b32 v92, 0
    v_mov_b32 v93, 0
    v_mov_b32 v94, 0
    v_mov_b32 v95, 0
    v_mov_b32 v28, 0
    v_mov_b32 v29, 0
    v_mov_b32 v30, 0
    v_mov_b32 v31, 0
    s_barrier
    ds_read_b128 v[96:99], v10
    ds_read_b64_tr_b16 v[112:113], v18 offset:0
    ds_read_b64_tr_b16 v[114:115], v18 offset:1024
    ds_read_b64_tr_b16 v[116:117], v19 offset:0
    ds_read_b64_tr_b16 v[118:119], v19 offset:1024
    ds_read_b128 v[104:107], v14
    s_mov_b32 s29, 0
k1_kernel_loop3:
    s_waitcnt lgkmcnt(3)
    v_mfma_f32_32x32x16_bf16 v[32:47], v[112:115], v[96:99], v[32:47]
    ds_read_b128 v[100:103], v11
    ds_read_b64_tr_b16 v[124:125], v18 offset:4096
    s_waitcnt lgkmcnt(3)
    v_mfma_f32_32x32x16_bf16 v[48:63], v[116:119], v[96:99], v[48:63]
    ds_read_b64_tr_b16 v[126:127], v18 offset:5120
    ds_read_b64_tr_b16 v[128:129], v19 offset:4096
    v_mfma_f32_16x16x32_bf16 v[28:31], v[24:27], v[112:115], v[28:31]
    s_waitcnt lgkmcnt(4)
    v_mfma_f32_32x32x16_bf16 v[64:79], v[112:115], v[104:107], v[64:79]
    ds_read_b64_tr_b16 v[130:131], v19 offset:5120
    ds_read_b128 v[108:111], v15
    s_waitcnt lgkmcnt(6)
    v_mfma_f32_32x32x16_bf16 v[80:95], v[116:119], v[104:107], v[80:95]
    s_waitcnt lgkmcnt(3)
    v_mfma_f32_32x32x16_bf16 v[32:47], v[124:127], v[100:103], v[32:47]
    s_barrier
    s_add_u32 s63, s63, 16384
    s_cmp_eq_u32 s63, 98304
    s_mov_b32 s55, 16384
    s_cselect_b32 s55, 0xfffec000, s55
    s_cselect_b32 s63, 0, s63
    v_add_u32 v18, s55, v18
    v_add_u32 v19, s55, v19
    ds_read_b128 v[96:99], v12
    ds_read_b64_tr_b16 v[112:113], v18 offset:0
    s_waitcnt lgkmcnt(3)
    v_mfma_f32_32x32x16_bf16 v[48:63], v[128:131], v[100:103], v[48:63]
    ds_read_b64_tr_b16 v[114:115], v18 offset:1024
    ds_read_b64_tr_b16 v[116:117], v19 offset:0
    v_mfma_f32_16x16x32_bf16 v[28:31], v[24:27], v[124:127], v[28:31]
    s_waitcnt lgkmcnt(4)
    v_mfma_f32_32x32x16_bf16 v[64:79], v[124:127], v[108:111], v[64:79]
    ds_read_b64_tr_b16 v[118:119], v19 offset:1024
    ds_read_b128 v[104:107], v16
    s_waitcnt lgkmcnt(6)
    v_mfma_f32_32x32x16_bf16 v[80:95], v[128:131], v[108:111], v[80:95]
    s_waitcnt lgkmcnt(3)
    v_mfma_f32_32x32x16_bf16 v[32:47], v[112:115], v[96:99], v[32:47]
    ds_read_b128 v[100:103], v13
    ds_read_b64_tr_b16 v[124:125], v18 offset:4096
    s_waitcnt lgkmcnt(3)
    v_mfma_f32_32x32x16_bf16 v[48:63], v[116:119], v[96:99], v[48:63]
    ds_read_b64_tr_b16 v[126:127], v18 offset:5120
    ds_read_b64_tr_b16 v[128:129], v19 offset:4096
    v_mfma_f32_16x16x32_bf16 v[28:31], v[24:27], v[112:115], v[28:31]
    s_waitcnt lgkmcnt(4)
    v_mfma_f32_32x32x16_bf16 v[64:79], v[112:115], v[104:107], v[64:79]
    ds_read_b64_tr_b16 v[130:131], v19 offset:5120
    ds_read_b128 v[108:111], v17
    s_waitcnt lgkmcnt(6)
    v_mfma_f32_32x32x16_bf16 v[80:95], v[116:119], v[104:107], v[80:95]
    s_waitcnt lgkmcnt(3)
    v_mfma_f32_32x32x16_bf16 v[32:47], v[124:127], v[100:103], v[32:47]
    s_barrier
    s_add_u32 s63, s63, 16384
    s_cmp_eq_u32 s63, 98304
    s_mov_b32 s55, 16384
    s_cselect_b32 s55, 0xfffec000, s55
    s_cselect_b32 s63, 0, s63
    v_add_u32 v18, s55, v18
    v_add_u32 v19, s55, v19
    s_add_u32 s56, s56, 16384
    s_cmp_eq_u32 s56, 49152
    s_mov_b32 s54, 16384
    s_cselect_b32 s54, 0xffff8000, s54
    s_cselect_b32 s56, 0, s56
    v_add_u32 v10, s54, v10
    v_add_u32 v11, s54, v11
    v_add_u32 v12, s54, v12
    v_add_u32 v13, s54, v13
    v_add_u32 v14, s54, v14
    v_add_u32 v15, s54, v15
    v_add_u32 v16, s54, v16
    v_add_u32 v17, s54, v17
    ds_read_b128 v[96:99], v10
    ds_read_b64_tr_b16 v[112:113], v18 offset:0
    s_waitcnt lgkmcnt(3)
    v_mfma_f32_32x32x16_bf16 v[48:63], v[128:131], v[100:103], v[48:63]
    ds_read_b64_tr_b16 v[114:115], v18 offset:1024
    ds_read_b64_tr_b16 v[116:117], v19 offset:0
    v_mfma_f32_16x16x32_bf16 v[28:31], v[24:27], v[124:127], v[28:31]
    s_waitcnt lgkmcnt(4)
    v_mfma_f32_32x32x16_bf16 v[64:79], v[124:127], v[108:111], v[64:79]
    ds_read_b64_tr_b16 v[118:119], v19 offset:1024
    ds_read_b128 v[104:107], v14
    s_waitcnt lgkmcnt(6)
    v_mfma_f32_32x32x16_bf16 v[80:95], v[128:131], v[108:111], v[80:95]
    s_add_u32 s29, s29, 1
    s_cmp_lt_u32 s29, 8
    s_cbranch_scc1 k1_kernel_loop3
    s_nop 7
    s_lshl_b32 s53, s43, 7
    s_add_u32 s53, s53, 147456
    v_lshlrev_b32 v3, 2, v1
    v_add_u32 v3, s53, v3
    s_mov_b64 exec, 0xffff
    ds_write_b32 v3, v28
    ds_write_b32 v3, v29 offset:64
    s_mov_b64 exec, -1
k1_kernel_nosw4:
    s_lshr_b32 s53, s24, 1
    s_lshl_b32 s53, s53, 15
    s_and_b32 s54, s24, 1
    s_lshl_b32 s54, s54, 13
    s_add_u32 s53, s53, s54
    v_lshlrev_b32 v3, 4, v1
    v_add_u32 v3, s53, v3
    ds_write_b128 v3, v[64:67] offset:0
    ds_write_b128 v3, v[68:71] offset:1024
    ds_write_b128 v3, v[72:75] offset:2048
    ds_write_b128 v3, v[76:79] offset:3072
    ds_write_b128 v3, v[80:83] offset:4096
    ds_write_b128 v3, v[84:87] offset:5120
    ds_write_b128 v3, v[88:91] offset:6144
    ds_write_b128 v3, v[92:95] offset:7168
    s_cmp_ge_u32 s24, 2
    s_cbranch_scc1 k1_kernel_nobias5
    s_waitcnt vmcnt(0)
    v_lshlrev_b32 v3, 16, v21
    v_mul_f32 v3, 0x3fb8aa3b, v3
    v_lshlrev_b32 v4, 2, v0
    v_add_u32 v4, 149504, v4
    ds_write_b32 v4, v3
k1_kernel_nobias5:
    s_waitcnt lgkmcnt(0)
    s_barrier
    v_lshlrev_b32 v5, 4, v8
    v_add_u32 v5, 147456, v5
    v_lshlrev_b32 v6, 4, v1
    s_lshl_b32 s29, s27, 2
k1_fepi:
    s_lshl_b32 s53, s59, 7
    v_lshlrev_b32 v4, 2, v9
    v_add_u32 v4, s53, v4
    v_add_u32 v4, 148480, v4
    ds_read_b32 v10, v4
    ds_read_b32 v11, v4 offset:512
    v_mov_b32 v22, 2.0
    v_mov_b32 v23, 2.0
    v_mov_b32 v24, 0xbfb17218
    v_mov_b32 v25, 0xbfb17218
    v_mov_b32 v26, 0x3f317218
    v_mov_b32 v27, 0x3f317218
    s_lshl_b32 s53, s43, 7
    v_add_u32 v7, s53, v5
    ds_read_b128 v[96:99], v7 offset:0
    ds_read_b128 v[112:115], v7 offset:2048
    ds_read_b128 v[100:103], v7 offset:32
    ds_read_b128 v[116:119], v7 offset:2080
    ds_read_b128 v[104:107], v7 offset:64
    ds_read_b128 v[120:123], v7 offset:2112
    ds_read_b128 v[108:111], v7 offset:96
    ds_read_b128 v[124:127], v7 offset:2144
    s_waitcnt lgkmcnt(8)
    v_mul_f32 v14, 0x3fb8aa3b, v10
    v_mul_f32 v16, 0x3fb8aa3b, v11
    v_mul_f32 v15, 0x3fb8aa3b, v10
    v_mul_f32 v17, 0x3fb8aa3b, v11
    s_lshl_b32 s53, s52, 7
    v_add_u32 v7, s53, v5
    ds_read_b128 v[128:131], v7 offset:0
    ds_read_b128 v[144:147], v7 offset:2048
    ds_read_b128 v[132:135], v7 offset:32
    ds_read_b128 v[148:151], v7 offset:2080
    ds_read_b128 v[136:139], v7 offset:64
    ds_read_b128 v[152:155], v7 offset:2112
    ds_read_b128 v[140:143], v7 offset:96
    ds_read_b128 v[156:159], v7 offset:2144
    s_cmp_ge_u32 s43, s69
    s_cbranch_scc1 k1_kernel_noslot6
    s_add_u32 s53, s29, s59
    s_mul_i32 s53, s53, 144
    s_add_u32 s54, s57, s43
    s_lshl_b32 s54, s54, 1
    s_add_u32 s53, s53, s54
    s_add_u32 s53, s53, 32
    s_lshl_b32 s53, s53, 10
    s_add_u32 s70, s53, 0x600000
    s_waitcnt lgkmcnt(8)
    v_pk_fma_f32 v[112:113], v[16:17], v[96:97], v[112:113] neg_lo:[1,0,0] neg_hi:[1,0,0]
    v_pk_fma_f32 v[114:115], v[16:17], v[98:99], v[114:115] neg_lo:[1,0,0] neg_hi:[1,0,0]
    v_pk_fma_f32 v[116:117], v[16:17], v[100:101], v[116:117] neg_lo:[1,0,0] neg_hi:[1,0,0]
    v_pk_fma_f32 v[118:119], v[16:17], v[102:103], v[118:119] neg_lo:[1,0,0] neg_hi:[1,0,0]
    v_pk_fma_f32 v[120:121], v[16:17], v[104:105], v[120:121] neg_lo:[1,0,0] neg_hi:[1,0,0]
    v_pk_fma_f32 v[122:123], v[16:17], v[106:107], v[122:123] neg_lo:[1,0,0] neg_hi:[1,0,0]
    v_pk_fma_f32 v[124:125], v[16:17], v[108:109], v[124:125] neg_lo:[1,0,0] neg_hi:[1,0,0]
    v_pk_fma_f32 v[126:127], v[16:17], v[110:111], v[126:127] neg_lo:[1,0,0] neg_hi:[1,0,0]
    v_pk_fma_f32 v[32:33], v[32:33], v[14:15], v[112:113]
    v_pk_fma_f32 v[34:35], v[34:35], v[14:15], v[114:115]
    v_pk_fma_f32 v[36:37], v[36:37], v[14:15], v[116:117]
    v_pk_fma_f32 v[38:39], v[38:39], v[14:15], v[118:119]
    v_pk_fma_f32 v[40:41], v[40:41], v[14:15], v[120:121]
    v_pk_fma_f32 v[42:43], v[42:43], v[14:15], v[122:123]
    v_pk_fma_f32 v[44:45], v[44:45], v[14:15], v[124:125]
    v_pk_fma_f32 v[46:47], v[46:47], v[14:15], v[126:127]
    v_exp_f32 v96, v32
    v_exp_f32 v97, v33
    v_exp_f32 v98, v34
    v_exp_f32 v99, v35
    v_exp_f32 v100, v36
    v_exp_f32 v101, v37
    v_exp_f32 v102, v38
    v_exp_f32 v103, v39
    v_exp_f32 v104, v40
    v_exp_f32 v105, v41
    v_exp_f32 v106, v42
    v_exp_f32 v107, v43
    v_exp_f32 v108, v44
    v_exp_f32 v109, v45
    v_exp_f32 v110, v46
    v_exp_f32 v111, v47
    v_pk_add_f32 v[112:113], v[96:97], v[22:23]
    v_pk_add_f32 v[114:115], v[98:99], v[22:23]
    v_pk_add_f32 v[116:117], v[100:101], v[22:23]
    v_pk_add_f32 v[118:119], v[102:103], v[22:23]
    v_pk_add_f32 v[120:121], v[104:105], v[22:23]
    v_pk_add_f32 v[122:123], v[106:107], v[22:23]
    v_pk_add_f32 v[124:125], v[108:109], v[22:23]
    v_pk_add_f32 v[126:127], v[110:111], v[22:23]
    v_pk_fma_f32 v[96:97], v[96:97], v[112:113], v[22:23]
    v_pk_fma_f32 v[98:99], v[98:99], v[114:115], v[22:23]
    v_pk_fma_f32 v[100:101], v[100:101], v[116:117], v[22:23]
    v_pk_fma_f32 v[102:103], v[102:103], v[118:119], v[22:23]
    v_pk_fma_f32 v[104:105], v[104:105], v[120:121], v[22:23]
    v_pk_fma_f32 v[106:107], v[106:107], v[122:123], v[22:23]
    v_pk_fma_f32 v[108:109], v[108:109], v[124:125], v[22:23]
    v_pk_fma_f32 v[110:111], v[110:111], v[126:127], v[22:23]
    v_rcp_f32 v96, v96
    v_rcp_f32 v97, v97
    v_rcp_f32 v98, v98
    v_rcp_f32 v99, v99
    v_rcp_f32 v100, v100
    v_rcp_f32 v101, v101
    v_rcp_f32 v102, v102
    v_rcp_f32 v103, v103
    v_rcp_f32 v104, v104
    v_rcp_f32 v105, v105
    v_rcp_f32 v106, v106
    v_rcp_f32 v107, v107
    v_rcp_f32 v108, v108
    v_rcp_f32 v109, v109
    v_rcp_f32 v110, v110
    v_rcp_f32 v111, v111
    v_pk_fma_f32 v[96:97], v[96:97], v[24:25], v[26:27]
    v_pk_fma_f32 v[98:99], v[98:99], v[24:25], v[26:27]
    v_pk_fma_f32 v[100:101], v[100:101], v[24:25], v[26:27]
    v_pk_fma_f32 v[102:103], v[102:103], v[24:25], v[26:27]
    v_pk_fma_f32 v[104:105], v[104:105], v[24:25], v[26:27]
    v_pk_fma_f32 v[106:107], v[106:107], v[24:25], v[26:27]
    v_pk_fma_f32 v[108:109], v[108:109], v[24:25], v[26:27]
    v_pk_fma_f32 v[110:111], v[110:111], v[24:25], v[26:27]
    v_pk_mul_f32 v[32:33], v[32:33], v[96:97]
    v_pk_mul_f32 v[34:35], v[34:35], v[98:99]
    v_pk_mul_f32 v[36:37], v[36:37], v[100:101]
    v_pk_mul_f32 v[38:39], v[38:39], v[102:103]
    v_pk_mul_f32 v[40:41], v[40:41], v[104:105]
    v_pk_mul_f32 v[42:43], v[42:43], v[106:107]
    v_pk_mul_f32 v[44:45], v[44:45], v[108:109]
    v_pk_mul_f32 v[46:47], v[46:47], v[110:111]
    v_cvt_pk_bf16_f32 v160, v32, v33
    v_cvt_pk_bf16_f32 v161, v34, v35
    v_cvt_pk_bf16_f32 v162, v36, v37
    v_cvt_pk_bf16_f32 v163, v38, v39
    v_cvt_pk_bf16_f32 v164, v40, v41
    v_cvt_pk_bf16_f32 v165, v42, v43
    v_cvt_pk_bf16_f32 v166, v44, v45
    v_cvt_pk_bf16_f32 v167, v46, v47
    buffer_store_dwordx4 v[160:163], v6, s[12:15], s70 offen sc1
    buffer_store_dwordx4 v[164:167], v6, s[12:15], s70 offen offset:1024 sc1
    s_nop 1
    s_add_u32 s53, s29, s59
    s_mul_i32 s53, s53, 144
    s_add_u32 s54, s57, s52
    s_lshl_b32 s54, s54, 1
    s_add_u32 s53, s53, s54
    s_add_u32 s53, s53, 32
    s_lshl_b32 s53, s53, 10
    s_add_u32 s70, s53, 0x600000
    s_waitcnt lgkmcnt(0)
    v_pk_fma_f32 v[144:145], v[16:17], v[128:129], v[144:145] neg_lo:[1,0,0] neg_hi:[1,0,0]
    v_pk_fma_f32 v[146:147], v[16:17], v[130:131], v[146:147] neg_lo:[1,0,0] neg_hi:[1,0,0]
    v_pk_fma_f32 v[148:149], v[16:17], v[132:133], v[148:149] neg_lo:[1,0,0] neg_hi:[1,0,0]
    v_pk_fma_f32 v[150:151], v[16:17], v[134:135], v[150:151] neg_lo:[1,0,0] neg_hi:[1,0,0]
    v_pk_fma_f32 v[152:153], v[16:17], v[136:137], v[152:153] neg_lo:[1,0,0] neg_hi:[1,0,0]
    v_pk_fma_f32 v[154:155], v[16:17], v[138:139], v[154:155] neg_lo:[1,0,0] neg_hi:[1,0,0]
    v_pk_fma_f32 v[156:157], v[16:17], v[140:141], v[156:157] neg_lo:[1,0,0] neg_hi:[1,0,0]
    v_pk_fma_f32 v[158:159], v[16:17], v[142:143], v[158:159] neg_lo:[1,0,0] neg_hi:[1,0,0]
    v_pk_fma_f32 v[48:49], v[48:49], v[14:15], v[144:145]
    v_pk_fma_f32 v[50:51], v[50:51], v[14:15], v[146:147]
    v_pk_fma_f32 v[52:53], v[52:53], v[14:15], v[148:149]
    v_pk_fma_f32 v[54:55], v[54:55], v[14:15], v[150:151]
    v_pk_fma_f32 v[56:57], v[56:57], v[14:15], v[152:153]
    v_pk_fma_f32 v[58:59], v[58:59], v[14:15], v[154:155]
    v_pk_fma_f32 v[60:61], v[60:61], v[14:15], v[156:157]
    v_pk_fma_f32 v[62:63], v[62:63], v[14:15], v[158:159]
    v_exp_f32 v128, v48
    v_exp_f32 v129, v49
    v_exp_f32 v130, v50
    v_exp_f32 v131, v51
    v_exp_f32 v132, v52
    v_exp_f32 v133, v53
    v_exp_f32 v134, v54
    v_exp_f32 v135, v55
    v_exp_f32 v136, v56
    v_exp_f32 v137, v57
    v_exp_f32 v138, v58
    v_exp_f32 v139, v59
    v_exp_f32 v140, v60
    v_exp_f32 v141, v61
    v_exp_f32 v142, v62
    v_exp_f32 v143, v63
    v_pk_add_f32 v[144:145], v[128:129], v[22:23]
    v_pk_add_f32 v[146:147], v[130:131], v[22:23]
    v_pk_add_f32 v[148:149], v[132:133], v[22:23]
    v_pk_add_f32 v[150:151], v[134:135], v[22:23]
    v_pk_add_f32 v[152:153], v[136:137], v[22:23]
    v_pk_add_f32 v[154:155], v[138:139], v[22:23]
    v_pk_add_f32 v[156:157], v[140:141], v[22:23]
    v_pk_add_f32 v[158:159], v[142:143], v[22:23]
    v_pk_fma_f32 v[128:129], v[128:129], v[144:145], v[22:23]
    v_pk_fma_f32 v[130:131], v[130:131], v[146:147], v[22:23]
    v_pk_fma_f32 v[132:133], v[132:133], v[148:149], v[22:23]
    v_pk_fma_f32 v[134:135], v[134:135], v[150:151], v[22:23]
    v_pk_fma_f32 v[136:137], v[136:137], v[152:153], v[22:23]
    v_pk_fma_f32 v[138:139], v[138:139], v[154:155], v[22:23]
    v_pk_fma_f32 v[140:141], v[140:141], v[156:157], v[22:23]
    v_pk_fma_f32 v[142:143], v[142:143], v[158:159], v[22:23]
    v_rcp_f32 v128, v128
    v_rcp_f32 v129, v129
    v_rcp_f32 v130, v130
    v_rcp_f32 v131, v131
    v_rcp_f32 v132, v132
    v_rcp_f32 v133, v133
    v_rcp_f32 v134, v134
    v_rcp_f32 v135, v135
    v_rcp_f32 v136, v136
    v_rcp_f32 v137, v137
    v_rcp_f32 v138, v138
    v_rcp_f32 v139, v139
    v_rcp_f32 v140, v140
    v_rcp_f32 v141, v141
    v_rcp_f32 v142, v142
    v_rcp_f32 v143, v143
    v_pk_fma_f32 v[128:129], v[128:129], v[24:25], v[26:27]
    v_pk_fma_f32 v[130:131], v[130:131], v[24:25], v[26:27]
    v_pk_fma_f32 v[132:133], v[132:133], v[24:25], v[26:27]
    v_pk_fma_f32 v[134:135], v[134:135], v[24:25], v[26:27]
    v_pk_fma_f32 v[136:137], v[136:137], v[24:25], v[26:27]
    v_pk_fma_f32 v[138:139], v[138:139], v[24:25], v[26:27]
    v_pk_fma_f32 v[140:141], v[140:141], v[24:25], v[26:27]
    v_pk_fma_f32 v[142:143], v[142:143], v[24:25], v[26:27]
    v_pk_mul_f32 v[48:49], v[48:49], v[128:129]
    v_pk_mul_f32 v[50:51], v[50:51], v[130:131]
    v_pk_mul_f32 v[52:53], v[52:53], v[132:133]
    v_pk_mul_f32 v[54:55], v[54:55], v[134:135]
    v_pk_mul_f32 v[56:57], v[56:57], v[136:137]
    v_pk_mul_f32 v[58:59], v[58:59], v[138:139]
    v_pk_mul_f32 v[60:61], v[60:61], v[140:141]
    v_pk_mul_f32 v[62:63], v[62:63], v[142:143]
    v_cvt_pk_bf16_f32 v160, v48, v49
    v_cvt_pk_bf16_f32 v161, v50, v51
    v_cvt_pk_bf16_f32 v162, v52, v53
    v_cvt_pk_bf16_f32 v163, v54, v55
    v_cvt_pk_bf16_f32 v164, v56, v57
    v_cvt_pk_bf16_f32 v165, v58, v59
    v_cvt_pk_bf16_f32 v166, v60, v61
    v_cvt_pk_bf16_f32 v167, v62, v63
    buffer_store_dwordx4 v[160:163], v6, s[12:15], s70 offen sc1
    buffer_store_dwordx4 v[164:167], v6, s[12:15], s70 offen offset:1024 sc1
    s_nop 1
k1_kernel_noslot6:
    s_endpgm
k1_kernel_role12:
    s_cmp_eq_u32 s28, 10
    s_cbranch_scc1 k1_kernel_ttn7
    s_cmp_gt_u32 s28, 10
    s_cbranch_scc1 k1_kernel_nnn8
    s_mov_b32 s59, s25
    s_lshl_b32 s53, s25, 12
    v_add_u32 v10, s53, v4
    v_xor_b32 v11, 32, v10
    v_xor_b32 v12, 64, v10
    v_xor_b32 v13, 96, v10
    s_add_u32 s43, s25, 0
    s_cmp_ge_u32 s43, 3
    s_cselect_b32 s53, 3, 0
    s_sub_u32 s43, s43, s53
    s_cmp_ge_u32 s43, 3
    s_cselect_b32 s53, 3, 0
    s_sub_u32 s43, s43, s53
    v_xor_b32 v7, s43, v6
    v_lshl_add_u32 v18, v7, 6, v5
    s_add_u32 s52, s25, 1
    s_cmp_ge_u32 s52, 3
    s_cselect_b32 s53, 3, 0
    s_sub_u32 s52, s52, s53
    s_cmp_ge_u32 s52, 3
    s_cselect_b32 s53, 3, 0
    s_sub_u32 s52, s52, s53
    v_xor_b32 v7, s52, v6
    v_lshl_add_u32 v19, v7, 6, v5
    s_add_u32 s42, s25, 2
    s_cmp_ge_u32 s42, 3
    s_cselect_b32 s53, 3, 0
    s_sub_u32 s42, s42, s53
    s_cmp_ge_u32 s42, 3
    s_cselect_b32 s53, 3, 0
    s_sub_u32 s42, s42, s53
    v_xor_b32 v7, s42, v6
    v_lshl_add_u32 v20, v7, 6, v5
    v_mov_b32 v32, 0
    v_mov_b32 v33, 0
    v_mov_b32 v34, 0
    v_mov_b32 v35, 0
    v_mov_b32 v36, 0
    v_mov_b32 v37, 0
    v_mov_b32 v38, 0
    v_mov_b32 v39, 0
    v_mov_b32 v40, 0
    v_mov_b32 v41, 0
    v_mov_b32 v42, 0
    v_mov_b32 v43, 0
    v_mov_b32 v44, 0
    v_mov_b32 v45, 0
    v_mov_b32 v46, 0
    v_mov_b32 v47, 0
    v_mov_b32 v48, 0
    v_mov_b32 v49, 0
    v_mov_b32 v50, 0
    v_mov_b32 v51, 0
    v_mov_b32 v52, 0
    v_mov_b32 v53, 0
    v_mov_b32 v54, 0
    v_mov_b32 v55, 0
    v_mov_b32 v56, 0
    v_mov_b32 v57, 0
    v_mov_b32 v58, 0
    v_mov_b32 v59, 0
    v_mov_b32 v60, 0
    v_mov_b32 v61, 0
    v_mov_b32 v62, 0
    v_mov_b32 v63, 0
    v_mov_b32 v64, 0
    v_mov_b32 v65, 0
    v_mov_b32 v66, 0
    v_mov_b32 v67, 0
    v_mov_b32 v68, 0
    v_mov_b32 v69, 0
    v_mov_b32 v70, 0
    v_mov_b32 v71, 0
    v_mov_b32 v72, 0
    v_mov_b32 v73, 0
    v_mov_b32 v74, 0
    v_mov_b32 v75, 0
    v_mov_b32 v76, 0
    v_mov_b32 v77, 0
    v_mov_b32 v78, 0
    v_mov_b32 v79, 0
    v_mov_b32 v28, 0
    v_mov_b32 v29, 0
    v_mov_b32 v30, 0
    v_mov_b32 v31, 0
    s_barrier
    ds_read_b128 v[96:99], v10
    ds_read_b64_tr_b16 v[112:113], v18 offset:8192
    ds_read_b64_tr_b16 v[114:115], v18 offset:9216
    ds_read_b64_tr_b16 v[116:117], v19 offset:8192
    ds_read_b64_tr_b16 v[118:119], v19 offset:9216
    ds_read_b64_tr_b16 v[120:121], v20 offset:8192
    ds_read_b64_tr_b16 v[122:123], v20 offset:9216
    s_mov_b32 s29, 0
k1_kernel_loop9:
    s_waitcnt lgkmcnt(4)
    v_mfma_f32_32x32x16_bf16 v[32:47], v[112:115], v[96:99], v[32:47]
    ds_read_b128 v[100:103], v11
    ds_read_b64_tr_b16 v[124:125], v18 offset:12288
    ds_read_b64_tr_b16 v[126:127], v18 offset:13312
    s_waitcnt lgkmcnt(5)
    v_mfma_f32_32x32x16_bf16 v[48:63], v[116:119], v[96:99], v[48:63]
    ds_read_b64_tr_b16 v[128:129], v19 offset:12288
    ds_read_b64_tr_b16 v[130:131], v19 offset:13312
    ds_read_b64_tr_b16 v[132:133], v20 offset:12288
    v_mfma_f32_16x16x32_bf16 v[28:31], v[24:27], v[112:115], v[28:31]
    s_waitcnt lgkmcnt(6)
    v_mfma_f32_32x32x16_bf16 v[64:79], v[120:123], v[96:99], v[64:79]
    ds_read_b64_tr_b16 v[134:135], v20 offset:13312
    s_waitcnt lgkmcnt(4)
    v_mfma_f32_32x32x16_bf16 v[32:47], v[124:127], v[100:103], v[32:47]
    s_barrier
    s_add_u32 s63, s63, 16384
    s_cmp_eq_u32 s63, 98304
    s_mov_b32 s55, 16384
    s_cselect_b32 s55, 0xfffec000, s55
    s_cselect_b32 s63, 0, s63
    v_add_u32 v18, s55, v18
    v_add_u32 v19, s55, v19
    v_add_u32 v20, s55, v20
    ds_read_b128 v[96:99], v12
    ds_read_b64_tr_b16 v[112:113], v18 offset:8192
    ds_read_b64_tr_b16 v[114:115], v18 offset:9216
    s_waitcnt lgkmcnt(5)
    v_mfma_f32_32x32x16_bf16 v[48:63], v[128:131], v[100:103], v[48:63]
    ds_read_b64_tr_b16 v[116:117], v19 offset:8192
    ds_read_b64_tr_b16 v[118:119], v19 offset:9216
    ds_read_b64_tr_b16 v[120:121], v20 offset:8192
    v_mfma_f32_16x16x32_bf16 v[28:31], v[24:27], v[124:127], v[28:31]
    s_waitcnt lgkmcnt(6)
    v_mfma_f32_32x32x16_bf16 v[64:79], v[132:135], v[100:103], v[64:79]
    ds_read_b64_tr_b16 v[122:123], v20 offset:9216
    s_waitcnt lgkmcnt(4)
    v_mfma_f32_32x32x16_bf16 v[32:47], v[112:115], v[96:99], v[32:47]
    ds_read_b128 v[100:103], v13
    ds_read_b64_tr_b16 v[124:125], v18 offset:12288
    ds_read_b64_tr_b16 v[126:127], v18 offset:13312
    s_waitcnt lgkmcnt(5)
    v_mfma_f32_32x32x16_bf16 v[48:63], v[116:119], v[96:99], v[48:63]
    ds_read_b64_tr_b16 v[128:129], v19 offset:12288
    ds_read_b64_tr_b16 v[130:131], v19 offset:13312
    ds_read_b64_tr_b16 v[132:133], v20 offset:12288
    v_mfma_f32_16x16x32_bf16 v[28:31], v[24:27], v[112:115], v[28:31]
    s_waitcnt lgkmcnt(6)
    v_mfma_f32_32x32x16_bf16 v[64:79], v[120:123], v[96:99], v[64:79]
    ds_read_b64_tr_b16 v[134:135], v20 offset:13312
    s_waitcnt lgkmcnt(4)
    v_mfma_f32_32x32x16_bf16 v[32:47], v[124:127], v[100:103], v[32:47]
    s_barrier
    s_add_u32 s63, s63, 16384
    s_cmp_eq_u32 s63, 98304
    s_mov_b32 s55, 16384
    s_cselect_b32 s55, 0xfffec000, s55
    s_cselect_b32 s63, 0, s63
    v_add_u32 v18, s55, v18
    v_add_u32 v19, s55, v19
    v_add_u32 v20, s55, v20
    s_add_u32 s56, s56, 16384
    s_cmp_eq_u32 s56, 49152
    s_mov_b32 s54, 16384
    s_cselect_b32 s54, 0xffff8000, s54
    s_cselect_b32 s56, 0, s56
    v_add_u32 v10, s54, v10
    v_add_u32 v11, s54, v11
    v_add_u32 v12, s54, v12
    v_add_u32 v13, s54, v13
    ds_read_b128 v[96:99], v10
    ds_read_b64_tr_b16 v[112:113], v18 offset:8192
    ds_read_b64_tr_b16 v[114:115], v18 offset:9216
    s_waitcnt lgkmcnt(5)
    v_mfma_f32_32x32x16_bf16 v[48:63], v[128:131], v[100:103], v[48:63]
    ds_read_b64_tr_b16 v[116:117], v19 offset:8192
    ds_read_b64_tr_b16 v[118:119], v19 offset:9216
    ds_read_b64_tr_b16 v[120:121], v20 offset:8192
    v_mfma_f32_16x16x32_bf16 v[28:31], v[24:27], v[124:127], v[28:31]
    s_waitcnt lgkmcnt(6)
    v_mfma_f32_32x32x16_bf16 v[64:79], v[132:135], v[100:103], v[64:79]
    ds_read_b64_tr_b16 v[122:123], v20 offset:9216
    s_add_u32 s29, s29, 1
    s_cmp_lt_u32 s29, 8
    s_cbranch_scc1 k1_kernel_loop9
    s_nop 7
    s_lshl_b32 s53, s43, 7
    s_add_u32 s53, s53, 147968
    v_lshlrev_b32 v3, 2, v1
    v_add_u32 v3, s53, v3
    s_mov_b64 exec, 0xffff
    ds_write_b32 v3, v28
    ds_write_b32 v3, v29 offset:64
    s_mov_b64 exec, -1
k1_kernel_nosw10:
    s_waitcnt lgkmcnt(0)
    s_barrier
    v_lshlrev_b32 v5, 4, v8
    v_add_u32 v5, 147456, v5
    v_lshlrev_b32 v6, 4, v1
    s_lshl_b32 s29, s27, 2
    s_setprio 2
    s_lshl_b32 s53, s59, 7
    v_lshlrev_b32 v4, 2, v9
    v_add_u32 v4, s53, v4
    v_add_u32 v4, 148480, v4
    ds_read_b32 v10, v4
    ds_read_b32 v11, v4 offset:512
    s_add_u32 s70, s29, s59
    s_lshl_b32 s71, s43, 7
    v_add_u32 v7, s71, v5
    ds_read_b128 v[80:83], v7 offset:512
    ds_read_b128 v[84:87], v7 offset:544
    ds_read_b128 v[88:91], v7 offset:576
    ds_read_b128 v[92:95], v7 offset:608
    s_lshl_b32 s71, s52, 7
    v_add_u32 v7, s71, v5
    ds_read_b128 v[96:99], v7 offset:512
    ds_read_b128 v[100:103], v7 offset:544
    ds_read_b128 v[104:107], v7 offset:576
    ds_read_b128 v[108:111], v7 offset:608
    s_waitcnt lgkmcnt(8)
    s_lshl_b32 s71, s42, 7
    v_add_u32 v7, s71, v5
    ds_read_b128 v[152:155], v7 offset:512
    ds_read_b128 v[156:159], v7 offset:544
    ds_read_b128 v[160:163], v7 offset:576
    ds_read_b128 v[164:167], v7 offset:608
    s_waitcnt lgkmcnt(0)
    s_add_u32 s54, s58, s43
    s_lshl_b32 s53, s54, 17
    s_lshl_b32 s55, s70, 10
    s_add_u32 s53, s53, s55
    s_cmp_lt_u32 s54, 16
    s_cselect_b32 s71, 0x3eb8aa3b, 1.0
    v_mul_f32 v14, s71, v10
    v_mul_f32 v15, s71, v11
    v_mul_f32 v80, v15, v80
    v_mul_f32 v81, v15, v81
    v_mul_f32 v82, v15, v82
    v_mul_f32 v83, v15, v83
    v_mul_f32 v84, v15, v84
    v_mul_f32 v85, v15, v85
    v_mul_f32 v86, v15, v86
    v_mul_f32 v87, v15, v87
    v_mul_f32 v88, v15, v88
    v_mul_f32 v89, v15, v89
    v_mul_f32 v90, v15, v90
    v_mul_f32 v91, v15, v91
    v_mul_f32 v92, v15, v92
    v_mul_f32 v93, v15, v93
    v_mul_f32 v94, v15, v94
    v_mul_f32 v95, v15, v95
    v_fma_f32 v32, v32, v14, -v80
    v_fma_f32 v33, v33, v14, -v81
    v_fma_f32 v34, v34, v14, -v82
    v_fma_f32 v35, v35, v14, -v83
    v_fma_f32 v36, v36, v14, -v84
    v_fma_f32 v37, v37, v14, -v85
    v_fma_f32 v38, v38, v14, -v86
    v_fma_f32 v39, v39, v14, -v87
    v_fma_f32 v40, v40, v14, -v88
    v_fma_f32 v41, v41, v14, -v89
    v_fma_f32 v42, v42, v14, -v90
    v_fma_f32 v43, v43, v14, -v91
    v_fma_f32 v44, v44, v14, -v92
    v_fma_f32 v45, v45, v14, -v93
    v_fma_f32 v46, v46, v14, -v94
    v_fma_f32 v47, v47, v14, -v95
    v_cvt_pk_bf16_f32 v112, v32, v33
    v_cvt_pk_bf16_f32 v113, v34, v35
    v_cvt_pk_bf16_f32 v114, v36, v37
    v_cvt_pk_bf16_f32 v115, v38, v39
    v_cvt_pk_bf16_f32 v116, v40, v41
    v_cvt_pk_bf16_f32 v117, v42, v43
    v_cvt_pk_bf16_f32 v118, v44, v45
    v_cvt_pk_bf16_f32 v119, v46, v47
    s_add_u32 s55, s53, 0x10000
    buffer_store_dwordx4 v[112:115], v6, s[12:15], s53 offen sc1
    buffer_store_dwordx4 v[116:119], v6, s[12:15], s55 offen sc1
    s_nop 1
    s_add_u32 s54, s58, s52
    s_lshl_b32 s53, s54, 17
    s_lshl_b32 s55, s70, 10
    s_add_u32 s53, s53, s55
    s_cmp_lt_u32 s54, 16
    s_cselect_b32 s71, 0x3eb8aa3b, 1.0
    v_mul_f32 v14, s71, v10
    v_mul_f32 v15, s71, v11
    v_mul_f32 v96, v15, v96
    v_mul_f32 v97, v15, v97
    v_mul_f32 v98, v15, v98
    v_mul_f32 v99, v15, v99
    v_mul_f32 v100, v15, v100
    v_mul_f32 v101, v15, v101
    v_mul_f32 v102, v15, v102
    v_mul_f32 v103, v15, v103
    v_mul_f32 v104, v15, v104
    v_mul_f32 v105, v15, v105
    v_mul_f32 v106, v15, v106
    v_mul_f32 v107, v15, v107
    v_mul_f32 v108, v15, v108
    v_mul_f32 v109, v15, v109
    v_mul_f32 v110, v15, v110
    v_mul_f32 v111, v15, v111
    v_fma_f32 v48, v48, v14, -v96
    v_fma_f32 v49, v49, v14, -v97
    v_fma_f32 v50, v50, v14, -v98
    v_fma_f32 v51, v51, v14, -v99
    v_fma_f32 v52, v52, v14, -v100
    v_fma_f32 v53, v53, v14, -v101
    v_fma_f32 v54, v54, v14, -v102
    v_fma_f32 v55, v55, v14, -v103
    v_fma_f32 v56, v56, v14, -v104
    v_fma_f32 v57, v57, v14, -v105
    v_fma_f32 v58, v58, v14, -v106
    v_fma_f32 v59, v59, v14, -v107
    v_fma_f32 v60, v60, v14, -v108
    v_fma_f32 v61, v61, v14, -v109
    v_fma_f32 v62, v62, v14, -v110
    v_fma_f32 v63, v63, v14, -v111
    v_cvt_pk_bf16_f32 v112, v48, v49
    v_cvt_pk_bf16_f32 v113, v50, v51
    v_cvt_pk_bf16_f32 v114, v52, v53
    v_cvt_pk_bf16_f32 v115, v54, v55
    v_cvt_pk_bf16_f32 v116, v56, v57
    v_cvt_pk_bf16_f32 v117, v58, v59
    v_cvt_pk_bf16_f32 v118, v60, v61
    v_cvt_pk_bf16_f32 v119, v62, v63
    s_add_u32 s55, s53, 0x10000
    buffer_store_dwordx4 v[112:115], v6, s[12:15], s53 offen sc1
    buffer_store_dwordx4 v[116:119], v6, s[12:15], s55 offen sc1
    s_nop 1
    s_add_u32 s54, s58, s42
    s_lshl_b32 s53, s54, 17
    s_lshl_b32 s55, s70, 10
    s_add_u32 s53, s53, s55
    s_cmp_lt_u32 s54, 16
    s_cselect_b32 s71, 0x3eb8aa3b, 1.0
    v_mul_f32 v14, s71, v10
    v_mul_f32 v15, s71, v11
    v_mul_f32 v152, v15, v152
    v_mul_f32 v153, v15, v153
    v_mul_f32 v154, v15, v154
    v_mul_f32 v155, v15, v155
    v_mul_f32 v156, v15, v156
    v_mul_f32 v157, v15, v157
    v_mul_f32 v158, v15, v158
    v_mul_f32 v159, v15, v159
    v_mul_f32 v160, v15, v160
    v_mul_f32 v161, v15, v161
    v_mul_f32 v162, v15, v162
    v_mul_f32 v163, v15, v163
    v_mul_f32 v164, v15, v164
    v_mul_f32 v165, v15, v165
    v_mul_f32 v166, v15, v166
    v_mul_f32 v167, v15, v167
    v_fma_f32 v64, v64, v14, -v152
    v_fma_f32 v65, v65, v14, -v153
    v_fma_f32 v66, v66, v14, -v154
    v_fma_f32 v67, v67, v14, -v155
    v_fma_f32 v68, v68, v14, -v156
    v_fma_f32 v69, v69, v14, -v157
    v_fma_f32 v70, v70, v14, -v158
    v_fma_f32 v71, v71, v14, -v159
    v_fma_f32 v72, v72, v14, -v160
    v_fma_f32 v73, v73, v14, -v161
    v_fma_f32 v74, v74, v14, -v162
    v_fma_f32 v75, v75, v14, -v163
    v_fma_f32 v76, v76, v14, -v164
    v_fma_f32 v77, v77, v14, -v165
    v_fma_f32 v78, v78, v14, -v166
    v_fma_f32 v79, v79, v14, -v167
    v_cvt_pk_bf16_f32 v112, v64, v65
    v_cvt_pk_bf16_f32 v113, v66, v67
    v_cvt_pk_bf16_f32 v114, v68, v69
    v_cvt_pk_bf16_f32 v115, v70, v71
    v_cvt_pk_bf16_f32 v116, v72, v73
    v_cvt_pk_bf16_f32 v117, v74, v75
    v_cvt_pk_bf16_f32 v118, v76, v77
    v_cvt_pk_bf16_f32 v119, v78, v79
    s_add_u32 s55, s53, 0x10000
    buffer_store_dwordx4 v[112:115], v6, s[12:15], s53 offen sc1
    buffer_store_dwordx4 v[116:119], v6, s[12:15], s55 offen sc1
    s_nop 1
    s_endpgm
k1_kernel_ttn7:
    s_mov_b32 s59, s25
    s_lshl_b32 s53, s25, 12
    v_add_u32 v10, s53, v4
    v_xor_b32 v11, 32, v10
    v_xor_b32 v12, 64, v10
    v_xor_b32 v13, 96, v10
    s_mov_b32 s43, 0
    v_xor_b32 v7, s43, v6
    v_lshl_add_u32 v18, v7, 6, v5
    s_mov_b32 s52, 1
    v_xor_b32 v7, s52, v6
    v_lshl_add_u32 v19, v7, 6, v5
    s_mov_b32 s42, 2
    v_xor_b32 v7, s42, v6
    v_lshl_add_u32 v20, v7, 6, v5
    v_mov_b32 v32, 0
    v_mov_b32 v33, 0
    v_mov_b32 v34, 0
    v_mov_b32 v35, 0
    v_mov_b32 v36, 0
    v_mov_b32 v37, 0
    v_mov_b32 v38, 0
    v_mov_b32 v39, 0
    v_mov_b32 v40, 0
    v_mov_b32 v41, 0
    v_mov_b32 v42, 0
    v_mov_b32 v43, 0
    v_mov_b32 v44, 0
    v_mov_b32 v45, 0
    v_mov_b32 v46, 0
    v_mov_b32 v47, 0
    v_mov_b32 v48, 0
    v_mov_b32 v49, 0
    v_mov_b32 v50, 0
    v_mov_b32 v51, 0
    v_mov_b32 v52, 0
    v_mov_b32 v53, 0
    v_mov_b32 v54, 0
    v_mov_b32 v55, 0
    v_mov_b32 v56, 0
    v_mov_b32 v57, 0
    v_mov_b32 v58, 0
    v_mov_b32 v59, 0
    v_mov_b32 v60, 0
    v_mov_b32 v61, 0
    v_mov_b32 v62, 0
    v_mov_b32 v63, 0
    v_mov_b32 v64, 0
    v_mov_b32 v65, 0
    v_mov_b32 v66, 0
    v_mov_b32 v67, 0
    v_mov_b32 v68, 0
    v_mov_b32 v69, 0
    v_mov_b32 v70, 0
    v_mov_b32 v71, 0
    v_mov_b32 v72, 0
    v_mov_b32 v73, 0
    v_mov_b32 v74, 0
    v_mov_b32 v75, 0
    v_mov_b32 v76, 0
    v_mov_b32 v77, 0
    v_mov_b32 v78, 0
    v_mov_b32 v79, 0
    v_mov_b32 v28, 0
    v_mov_b32 v29, 0
    v_mov_b32 v30, 0
    v_mov_b32 v31, 0
    s_barrier
    ds_read_b128 v[96:99], v10
    ds_read_b64_tr_b16 v[112:113], v18 offset:8192
    ds_read_b64_tr_b16 v[114:115], v18 offset:9216
    ds_read_b64_tr_b16 v[116:117], v19 offset:8192
    ds_read_b64_tr_b16 v[118:119], v19 offset:9216
    ds_read_b64_tr_b16 v[120:121], v20 offset:8192
    ds_read_b64_tr_b16 v[122:123], v20 offset:9216
    s_mov_b32 s29, 0
k1_kernel_loop11:
    s_waitcnt lgkmcnt(4)
    v_mfma_f32_32x32x16_bf16 v[32:47], v[112:115], v[96:99], v[32:47]
    ds_read_b128 v[100:103], v11
    ds_read_b64_tr_b16 v[124:125], v18 offset:12288
    ds_read_b64_tr_b16 v[126:127], v18 offset:13312
    s_waitcnt lgkmcnt(5)
    v_mfma_f32_32x32x16_bf16 v[48:63], v[116:119], v[96:99], v[48:63]
    ds_read_b64_tr_b16 v[128:129], v19 offset:12288
    ds_read_b64_tr_b16 v[130:131], v19 offset:13312
    ds_read_b64_tr_b16 v[132:133], v20 offset:12288
    s_waitcnt lgkmcnt(6)
    v_mfma_f32_32x32x16_bf16 v[64:79], v[96:99], v[120:123], v[64:79]
    ds_read_b64_tr_b16 v[134:135], v20 offset:13312
    s_set_gpr_idx_on s68, gpr_idx(SRC0)
    s_nop 0
    v_mov_b32 v136, v112
    v_mov_b32 v137, v113
    v_mov_b32 v138, v114
    v_mov_b32 v139, v115
    s_set_gpr_idx_off
    s_nop 1
    v_mfma_f32_16x16x32_bf16 v[28:31], v[24:27], v[136:139], v[28:31]
    s_waitcnt lgkmcnt(4)
    v_mfma_f32_32x32x16_bf16 v[32:47], v[124:127], v[100:103], v[32:47]
    s_barrier
    s_add_u32 s63, s63, 16384
    s_cmp_eq_u32 s63, 98304
    s_mov_b32 s55, 16384
    s_cselect_b32 s55, 0xfffec000, s55
    s_cselect_b32 s63, 0, s63
    v_add_u32 v18, s55, v18
    v_add_u32 v19, s55, v19
    v_add_u32 v20, s55, v20
    ds_read_b128 v[96:99], v12
    ds_read_b64_tr_b16 v[112:113], v18 offset:8192
    ds_read_b64_tr_b16 v[114:115], v18 offset:9216
    s_waitcnt lgkmcnt(5)
    v_mfma_f32_32x32x16_bf16 v[48:63], v[128:131], v[100:103], v[48:63]
    ds_read_b64_tr_b16 v[116:117], v19 offset:8192
    ds_read_b64_tr_b16 v[118:119], v19 offset:9216
    ds_read_b64_tr_b16 v[120:121], v20 offset:8192
    s_waitcnt lgkmcnt(6)
    v_mfma_f32_32x32x16_bf16 v[64:79], v[100:103], v[132:135], v[64:79]
    ds_read_b64_tr_b16 v[122:123], v20 offset:9216
    s_set_gpr_idx_on s68, gpr_idx(SRC0)
    s_nop 0
    v_mov_b32 v136, v124
    v_mov_b32 v137, v125
    v_mov_b32 v138, v126
    v_mov_b32 v139, v127
    s_set_gpr_idx_off
    s_nop 1
    v_mfma_f32_16x16x32_bf16 v[28:31], v[24:27], v[136:139], v[28:31]
    s_waitcnt lgkmcnt(4)
    v_mfma_f32_32x32x16_bf16 v[32:47], v[112:115], v[96:99], v[32:47]
    ds_read_b128 v[100:103], v13
    ds_read_b64_tr_b16 v[124:125], v18 offset:12288
    ds_read_b64_tr_b16 v[126:127], v18 offset:13312
    s_waitcnt lgkmcnt(5)
    v_mfma_f32_32x32x16_bf16 v[48:63], v[116:119], v[96:99], v[48:63]
    ds_read_b64_tr_b16 v[128:129], v19 offset:12288
    ds_read_b64_tr_b16 v[130:131], v19 offset:13312
    ds_read_b64_tr_b16 v[132:133], v20 offset:12288
    s_waitcnt lgkmcnt(6)
    v_mfma_f32_32x32x16_bf16 v[64:79], v[96:99], v[120:123], v[64:79]
    ds_read_b64_tr_b16 v[134:135], v20 offset:13312
    s_set_gpr_idx_on s68, gpr_idx(SRC0)
    s_nop 0
    v_mov_b32 v136, v112
    v_mov_b32 v137, v113
    v_mov_b32 v138, v114
    v_mov_b32 v139, v115
    s_set_gpr_idx_off
    s_nop 1
    v_mfma_f32_16x16x32_bf16 v[28:31], v[24:27], v[136:139], v[28:31]
    s_waitcnt lgkmcnt(4)
    v_mfma_f32_32x32x16_bf16 v[32:47], v[124:127], v[100:103], v[32:47]
    s_barrier
    s_add_u32 s63, s63, 16384
    s_cmp_eq_u32 s63, 98304
    s_mov_b32 s55, 16384
    s_cselect_b32 s55, 0xfffec000, s55
    s_cselect_b32 s63, 0, s63
    v_add_u32 v18, s55, v18
    v_add_u32 v19, s55, v19
    v_add_u32 v20, s55, v20
    s_add_u32 s56, s56, 16384
    s_cmp_eq_u32 s56, 49152
    s_mov_b32 s54, 16384
    s_cselect_b32 s54, 0xffff8000, s54
    s_cselect_b32 s56, 0, s56
    v_add_u32 v10, s54, v10
    v_add_u32 v11, s54, v11
    v_add_u32 v12, s54, v12
    v_add_u32 v13, s54, v13
    ds_read_b128 v[96:99], v10
    ds_read_b64_tr_b16 v[112:113], v18 offset:8192
    ds_read_b64_tr_b16 v[114:115], v18 offset:9216
    s_waitcnt lgkmcnt(5)
    v_mfma_f32_32x32x16_bf16 v[48:63], v[128:131], v[100:103], v[48:63]
    ds_read_b64_tr_b16 v[116:117], v19 offset:8192
    ds_read_b64_tr_b16 v[118:119], v19 offset:9216
    ds_read_b64_tr_b16 v[120:121], v20 offset:8192
    s_waitcnt lgkmcnt(6)
    v_mfma_f32_32x32x16_bf16 v[64:79], v[100:103], v[132:135], v[64:79]
    ds_read_b64_tr_b16 v[122:123], v20 offset:9216
    s_set_gpr_idx_on s68, gpr_idx(SRC0)
    s_nop 0
    v_mov_b32 v136, v124
    v_mov_b32 v137, v125
    v_mov_b32 v138, v126
    v_mov_b32 v139, v127
    s_set_gpr_idx_off
    s_nop 1
    v_mfma_f32_16x16x32_bf16 v[28:31], v[24:27], v[136:139], v[28:31]
    s_add_u32 s29, s29, 1
    s_cmp_lt_u32 s29, 8
    s_cbranch_scc1 k1_kernel_loop11
    s_nop 7
    s_cmp_eq_u32 s25, 3
    s_cbranch_scc1 k1_kernel_nosw12
    s_lshl_b32 s53, s25, 7
    s_add_u32 s53, s53, 147968
    v_lshlrev_b32 v3, 2, v1
    v_add_u32 v3, s53, v3
    s_mov_b64 exec, 0xffff
    ds_write_b32 v3, v28
    ds_write_b32 v3, v29 offset:64
    s_mov_b64 exec, -1
k1_kernel_nosw12:
    s_waitcnt lgkmcnt(0)
    s_barrier
    v_lshlrev_b32 v5, 4, v8
    v_add_u32 v5, 147456, v5
    v_lshlrev_b32 v6, 4, v1
    s_lshl_b32 s29, s27, 2
    s_setprio 2
    s_lshl_b32 s53, s59, 7
    v_lshlrev_b32 v4, 2, v9
    v_add_u32 v4, s53, v4
    v_add_u32 v4, 148480, v4
    ds_read_b32 v10, v4
    ds_read_b32 v11, v4 offset:512
    s_lshl_b32 s53, s59, 7
    v_lshlrev_b32 v7, 4, v8
    v_add_u32 v7, s53, v7
    v_add_u32 v7, 148480, v7
    ds_read_b128 v[120:123], v7 offset:0
    ds_read_b128 v[136:139], v7 offset:512
    ds_read_b128 v[124:127], v7 offset:32
    ds_read_b128 v[140:143], v7 offset:544
    ds_read_b128 v[128:131], v7 offset:64
    ds_read_b128 v[144:147], v7 offset:576
    ds_read_b128 v[132:135], v7 offset:96
    ds_read_b128 v[148:151], v7 offset:608
    v_lshrrev_b32 v12, 4, v9
    v_lshlrev_b32 v12, 16, v12
    v_lshl_add_u32 v12, v8, 8, v12
    v_and_b32 v13, 15, v9
    v_lshl_add_u32 v12, v13, 4, v12
    s_add_u32 s70, s29, s59
    s_lshl_b32 s71, s43, 7
    v_add_u32 v7, s71, v5
    ds_read_b128 v[80:83], v7 offset:512
    ds_read_b128 v[84:87], v7 offset:544
    ds_read_b128 v[88:91], v7 offset:576
    ds_read_b128 v[92:95], v7 offset:608
    s_lshl_b32 s71, s52, 7
    v_add_u32 v7, s71, v5
    ds_read_b128 v[96:99], v7 offset:512
    ds_read_b128 v[100:103], v7 offset:544
    ds_read_b128 v[104:107], v7 offset:576
    ds_read_b128 v[108:111], v7 offset:608
    s_waitcnt lgkmcnt(8)
    s_lshl_b32 s71, s42, 7
    v_lshlrev_b32 v13, 2, v9
    v_add_u32 v13, s71, v13
    v_add_u32 v13, 147968, v13
    ds_read_b32 v18, v13
    s_waitcnt lgkmcnt(0)
    s_add_u32 s54, s58, s43
    s_lshl_b32 s53, s54, 17
    s_lshl_b32 s55, s70, 10
    s_add_u32 s53, s53, s55
    s_cmp_lt_u32 s54, 16
    s_cselect_b32 s71, 0x3eb8aa3b, 1.0
    v_mul_f32 v14, s71, v10
    v_mul_f32 v15, s71, v11
    v_mul_f32 v80, v15, v80
    v_mul_f32 v81, v15, v81
    v_mul_f32 v82, v15, v82
    v_mul_f32 v83, v15, v83
    v_mul_f32 v84, v15, v84
    v_mul_f32 v85, v15, v85
    v_mul_f32 v86, v15, v86
    v_mul_f32 v87, v15, v87
    v_mul_f32 v88, v15, v88
    v_mul_f32 v89, v15, v89
    v_mul_f32 v90, v15, v90
    v_mul_f32 v91, v15, v91
    v_mul_f32 v92, v15, v92
    v_mul_f32 v93, v15, v93
    v_mul_f32 v94, v15, v94
    v_mul_f32 v95, v15, v95
    v_fma_f32 v32, v32, v14, -v80
    v_fma_f32 v33, v33, v14, -v81
    v_fma_f32 v34, v34, v14, -v82
    v_fma_f32 v35, v35, v14, -v83
    v_fma_f32 v36, v36, v14, -v84
    v_fma_f32 v37, v37, v14, -v85
    v_fma_f32 v38, v38, v14, -v86
    v_fma_f32 v39, v39, v14, -v87
    v_fma_f32 v40, v40, v14, -v88
    v_fma_f32 v41, v41, v14, -v89
    v_fma_f32 v42, v42, v14, -v90
    v_fma_f32 v43, v43, v14, -v91
    v_fma_f32 v44, v44, v14, -v92
    v_fma_f32 v45, v45, v14, -v93
    v_fma_f32 v46, v46, v14, -v94
    v_fma_f32 v47, v47, v14, -v95
    v_cvt_pk_bf16_f32 v112, v32, v33
    v_cvt_pk_bf16_f32 v113, v34, v35
    v_cvt_pk_bf16_f32 v114, v36, v37
    v_cvt_pk_bf16_f32 v115, v38, v39
    v_cvt_pk_bf16_f32 v116, v40, v41
    v_cvt_pk_bf16_f32 v117, v42, v43
    v_cvt_pk_bf16_f32 v118, v44, v45
    v_cvt_pk_bf16_f32 v119, v46, v47
    s_add_u32 s55, s53, 0x10000
    buffer_store_dwordx4 v[112:115], v6, s[12:15], s53 offen sc1
    buffer_store_dwordx4 v[116:119], v6, s[12:15], s55 offen sc1
    s_nop 1
    s_add_u32 s54, s58, s52
    s_lshl_b32 s53, s54, 17
    s_lshl_b32 s55, s70, 10
    s_add_u32 s53, s53, s55
    s_cmp_lt_u32 s54, 16
    s_cselect_b32 s71, 0x3eb8aa3b, 1.0
    v_mul_f32 v14, s71, v10
    v_mul_f32 v15, s71, v11
    v_mul_f32 v96, v15, v96
    v_mul_f32 v97, v15, v97
    v_mul_f32 v98, v15, v98
    v_mul_f32 v99, v15, v99
    v_mul_f32 v100, v15, v100
    v_mul_f32 v101, v15, v101
    v_mul_f32 v102, v15, v102
    v_mul_f32 v103, v15, v103
    v_mul_f32 v104, v15, v104
    v_mul_f32 v105, v15, v105
    v_mul_f32 v106, v15, v106
    v_mul_f32 v107, v15, v107
    v_mul_f32 v108, v15, v108
    v_mul_f32 v109, v15, v109
    v_mul_f32 v110, v15, v110
    v_mul_f32 v111, v15, v111
    v_fma_f32 v48, v48, v14, -v96
    v_fma_f32 v49, v49, v14, -v97
    v_fma_f32 v50, v50, v14, -v98
    v_fma_f32 v51, v51, v14, -v99
    v_fma_f32 v52, v52, v14, -v100
    v_fma_f32 v53, v53, v14, -v101
    v_fma_f32 v54, v54, v14, -v102
    v_fma_f32 v55, v55, v14, -v103
    v_fma_f32 v56, v56, v14, -v104
    v_fma_f32 v57, v57, v14, -v105
    v_fma_f32 v58, v58, v14, -v106
    v_fma_f32 v59, v59, v14, -v107
    v_fma_f32 v60, v60, v14, -v108
    v_fma_f32 v61, v61, v14, -v109
    v_fma_f32 v62, v62, v14, -v110
    v_fma_f32 v63, v63, v14, -v111
    v_cvt_pk_bf16_f32 v112, v48, v49
    v_cvt_pk_bf16_f32 v113, v50, v51
    v_cvt_pk_bf16_f32 v114, v52, v53
    v_cvt_pk_bf16_f32 v115, v54, v55
    v_cvt_pk_bf16_f32 v116, v56, v57
    v_cvt_pk_bf16_f32 v117, v58, v59
    v_cvt_pk_bf16_f32 v118, v60, v61
    v_cvt_pk_bf16_f32 v119, v62, v63
    s_add_u32 s55, s53, 0x10000
    buffer_store_dwordx4 v[112:115], v6, s[12:15], s53 offen sc1
    buffer_store_dwordx4 v[116:119], v6, s[12:15], s55 offen sc1
    s_nop 1
    s_add_u32 s54, s58, s42
    s_lshl_b32 s53, s54, 17
    s_lshl_b32 s55, s70, 10
    s_add_u32 s53, s53, s55
    v_mul_f32 v80, v18, v136
    v_mul_f32 v81, v18, v137
    v_mul_f32 v82, v18, v138
    v_mul_f32 v83, v18, v139
    v_mul_f32 v84, v18, v140
    v_mul_f32 v85, v18, v141
    v_mul_f32 v86, v18, v142
    v_mul_f32 v87, v18, v143
    v_mul_f32 v88, v18, v144
    v_mul_f32 v89, v18, v145
    v_mul_f32 v90, v18, v146
    v_mul_f32 v91, v18, v147
    v_mul_f32 v92, v18, v148
    v_mul_f32 v93, v18, v149
    v_mul_f32 v94, v18, v150
    v_mul_f32 v95, v18, v151
    v_fma_f32 v64, v64, v120, -v80
    v_fma_f32 v65, v65, v121, -v81
    v_fma_f32 v66, v66, v122, -v82
    v_fma_f32 v67, v67, v123, -v83
    v_fma_f32 v68, v68, v124, -v84
    v_fma_f32 v69, v69, v125, -v85
    v_fma_f32 v70, v70, v126, -v86
    v_fma_f32 v71, v71, v127, -v87
    v_fma_f32 v72, v72, v128, -v88
    v_fma_f32 v73, v73, v129, -v89
    v_fma_f32 v74, v74, v130, -v90
    v_fma_f32 v75, v75, v131, -v91
    v_fma_f32 v76, v76, v132, -v92
    v_fma_f32 v77, v77, v133, -v93
    v_fma_f32 v78, v78, v134, -v94
    v_fma_f32 v79, v79, v135, -v95
    v_cvt_pk_bf16_f32 v112, v64, v65
    v_cvt_pk_bf16_f32 v113, v66, v67
    v_cvt_pk_bf16_f32 v114, v68, v69
    v_cvt_pk_bf16_f32 v115, v70, v71
    v_cvt_pk_bf16_f32 v116, v72, v73
    v_cvt_pk_bf16_f32 v117, v74, v75
    v_cvt_pk_bf16_f32 v118, v76, v77
    v_cvt_pk_bf16_f32 v119, v78, v79
    buffer_store_dwordx4 v[112:115], v12, s[12:15], s53 offen sc1
    buffer_store_dwordx4 v[116:119], v12, s[12:15], s53 offen offset:512 sc1
    s_nop 1
    s_endpgm
k1_kernel_nnn8:
    s_mov_b32 s59, s25
    s_lshl_b32 s53, s25, 12
    v_add_u32 v10, s53, v4
    v_xor_b32 v11, 32, v10
    v_xor_b32 v12, 64, v10
    v_xor_b32 v13, 96, v10
    s_add_u32 s43, s25, 0
    s_cmp_ge_u32 s43, 3
    s_cselect_b32 s53, 3, 0
    s_sub_u32 s43, s43, s53
    s_cmp_ge_u32 s43, 3
    s_cselect_b32 s53, 3, 0
    s_sub_u32 s43, s43, s53
    v_xor_b32 v7, s43, v6
    v_lshl_add_u32 v18, v7, 6, v5
    s_add_u32 s52, s25, 1
    s_cmp_ge_u32 s52, 3
    s_cselect_b32 s53, 3, 0
    s_sub_u32 s52, s52, s53
    s_cmp_ge_u32 s52, 3
    s_cselect_b32 s53, 3, 0
    s_sub_u32 s52, s52, s53
    v_xor_b32 v7, s52, v6
    v_lshl_add_u32 v19, v7, 6, v5
    s_add_u32 s42, s25, 2
    s_cmp_ge_u32 s42, 3
    s_cselect_b32 s53, 3, 0
    s_sub_u32 s42, s42, s53
    s_cmp_ge_u32 s42, 3
    s_cselect_b32 s53, 3, 0
    s_sub_u32 s42, s42, s53
    v_xor_b32 v7, s42, v6
    v_lshl_add_u32 v20, v7, 6, v5
    v_mov_b32 v32, 0
    v_mov_b32 v33, 0
    v_mov_b32 v34, 0
    v_mov_b32 v35, 0
    v_mov_b32 v36, 0
    v_mov_b32 v37, 0
    v_mov_b32 v38, 0
    v_mov_b32 v39, 0
    v_mov_b32 v40, 0
    v_mov_b32 v41, 0
    v_mov_b32 v42, 0
    v_mov_b32 v43, 0
    v_mov_b32 v44, 0
    v_mov_b32 v45, 0
    v_mov_b32 v46, 0
    v_mov_b32 v47, 0
    v_mov_b32 v48, 0
    v_mov_b32 v49, 0
    v_mov_b32 v50, 0
    v_mov_b32 v51, 0
    v_mov_b32 v52, 0
    v_mov_b32 v53, 0
    v_mov_b32 v54, 0
    v_mov_b32 v55, 0
    v_mov_b32 v56, 0
    v_mov_b32 v57, 0
    v_mov_b32 v58, 0
    v_mov_b32 v59, 0
    v_mov_b32 v60, 0
    v_mov_b32 v61, 0
    v_mov_b32 v62, 0
    v_mov_b32 v63, 0
    v_mov_b32 v64, 0
    v_mov_b32 v65, 0
    v_mov_b32 v66, 0
    v_mov_b32 v67, 0
    v_mov_b32 v68, 0
    v_mov_b32 v69, 0
    v_mov_b32 v70, 0
    v_mov_b32 v71, 0
    v_mov_b32 v72, 0
    v_mov_b32 v73, 0
    v_mov_b32 v74, 0
    v_mov_b32 v75, 0
    v_mov_b32 v76, 0
    v_mov_b32 v77, 0
    v_mov_b32 v78, 0
    v_mov_b32 v79, 0
    v_mov_b32 v28, 0
    v_mov_b32 v29, 0
    v_mov_b32 v30, 0
    v_mov_b32 v31, 0
    s_barrier
    ds_read_b128 v[96:99], v10
    ds_read_b64_tr_b16 v[112:113], v18 offset:8192
    ds_read_b64_tr_b16 v[114:115], v18 offset:9216
    ds_read_b64_tr_b16 v[116:117], v19 offset:8192
    ds_read_b64_tr_b16 v[118:119], v19 offset:9216
    ds_read_b64_tr_b16 v[120:121], v20 offset:8192
    ds_read_b64_tr_b16 v[122:123], v20 offset:9216
    s_mov_b32 s29, 0
k1_kernel_loop13:
    s_waitcnt lgkmcnt(4)
    v_mfma_f32_32x32x16_bf16 v[32:47], v[96:99], v[112:115], v[32:47]
    ds_read_b128 v[100:103], v11
    ds_read_b64_tr_b16 v[124:125], v18 offset:12288
    ds_read_b64_tr_b16 v[126:127], v18 offset:13312
    s_waitcnt lgkmcnt(5)
    v_mfma_f32_32x32x16_bf16 v[48:63], v[96:99], v[116:119], v[48:63]
    ds_read_b64_tr_b16 v[128:129], v19 offset:12288
    ds_read_b64_tr_b16 v[130:131], v19 offset:13312
    ds_read_b64_tr_b16 v[132:133], v20 offset:12288
    v_mfma_f32_16x16x32_bf16 v[28:31], v[24:27], v[112:115], v[28:31]
    s_waitcnt lgkmcnt(6)
    v_mfma_f32_32x32x16_bf16 v[64:79], v[96:99], v[120:123], v[64:79]
    ds_read_b64_tr_b16 v[134:135], v20 offset:13312
    s_waitcnt lgkmcnt(4)
    v_mfma_f32_32x32x16_bf16 v[32:47], v[100:103], v[124:127], v[32:47]
    s_barrier
    s_add_u32 s63, s63, 16384
    s_cmp_eq_u32 s63, 98304
    s_mov_b32 s55, 16384
    s_cselect_b32 s55, 0xfffec000, s55
    s_cselect_b32 s63, 0, s63
    v_add_u32 v18, s55, v18
    v_add_u32 v19, s55, v19
    v_add_u32 v20, s55, v20
    ds_read_b128 v[96:99], v12
    ds_read_b64_tr_b16 v[112:113], v18 offset:8192
    ds_read_b64_tr_b16 v[114:115], v18 offset:9216
    s_waitcnt lgkmcnt(5)
    v_mfma_f32_32x32x16_bf16 v[48:63], v[100:103], v[128:131], v[48:63]
    ds_read_b64_tr_b16 v[116:117], v19 offset:8192
    ds_read_b64_tr_b16 v[118:119], v19 offset:9216
    ds_read_b64_tr_b16 v[120:121], v20 offset:8192
    v_mfma_f32_16x16x32_bf16 v[28:31], v[24:27], v[124:127], v[28:31]
    s_waitcnt lgkmcnt(6)
    v_mfma_f32_32x32x16_bf16 v[64:79], v[100:103], v[132:135], v[64:79]
    ds_read_b64_tr_b16 v[122:123], v20 offset:9216
    s_waitcnt lgkmcnt(4)
    v_mfma_f32_32x32x16_bf16 v[32:47], v[96:99], v[112:115], v[32:47]
    ds_read_b128 v[100:103], v13
    ds_read_b64_tr_b16 v[124:125], v18 offset:12288
    ds_read_b64_tr_b16 v[126:127], v18 offset:13312
    s_waitcnt lgkmcnt(5)
    v_mfma_f32_32x32x16_bf16 v[48:63], v[96:99], v[116:119], v[48:63]
    ds_read_b64_tr_b16 v[128:129], v19 offset:12288
    ds_read_b64_tr_b16 v[130:131], v19 offset:13312
    ds_read_b64_tr_b16 v[132:133], v20 offset:12288
    v_mfma_f32_16x16x32_bf16 v[28:31], v[24:27], v[112:115], v[28:31]
    s_waitcnt lgkmcnt(6)
    v_mfma_f32_32x32x16_bf16 v[64:79], v[96:99], v[120:123], v[64:79]
    ds_read_b64_tr_b16 v[134:135], v20 offset:13312
    s_waitcnt lgkmcnt(4)
    v_mfma_f32_32x32x16_bf16 v[32:47], v[100:103], v[124:127], v[32:47]
    s_barrier
    s_add_u32 s63, s63, 16384
    s_cmp_eq_u32 s63, 98304
    s_mov_b32 s55, 16384
    s_cselect_b32 s55, 0xfffec000, s55
    s_cselect_b32 s63, 0, s63
    v_add_u32 v18, s55, v18
    v_add_u32 v19, s55, v19
    v_add_u32 v20, s55, v20
    s_add_u32 s56, s56, 16384
    s_cmp_eq_u32 s56, 49152
    s_mov_b32 s54, 16384
    s_cselect_b32 s54, 0xffff8000, s54
    s_cselect_b32 s56, 0, s56
    v_add_u32 v10, s54, v10
    v_add_u32 v11, s54, v11
    v_add_u32 v12, s54, v12
    v_add_u32 v13, s54, v13
    ds_read_b128 v[96:99], v10
    ds_read_b64_tr_b16 v[112:113], v18 offset:8192
    ds_read_b64_tr_b16 v[114:115], v18 offset:9216
    s_waitcnt lgkmcnt(5)
    v_mfma_f32_32x32x16_bf16 v[48:63], v[100:103], v[128:131], v[48:63]
    ds_read_b64_tr_b16 v[116:117], v19 offset:8192
    ds_read_b64_tr_b16 v[118:119], v19 offset:9216
    ds_read_b64_tr_b16 v[120:121], v20 offset:8192
    v_mfma_f32_16x16x32_bf16 v[28:31], v[24:27], v[124:127], v[28:31]
    s_waitcnt lgkmcnt(6)
    v_mfma_f32_32x32x16_bf16 v[64:79], v[100:103], v[132:135], v[64:79]
    ds_read_b64_tr_b16 v[122:123], v20 offset:9216
    s_add_u32 s29, s29, 1
    s_cmp_lt_u32 s29, 8
    s_cbranch_scc1 k1_kernel_loop13
    s_nop 7
    s_lshl_b32 s53, s43, 7
    s_add_u32 s53, s53, 147968
    v_lshlrev_b32 v3, 2, v1
    v_add_u32 v3, s53, v3
    s_mov_b64 exec, 0xffff
    ds_write_b32 v3, v28
    ds_write_b32 v3, v29 offset:64
    s_mov_b64 exec, -1
k1_kernel_nosw14:
    s_waitcnt lgkmcnt(0)
    s_barrier
    v_lshlrev_b32 v5, 4, v8
    v_add_u32 v5, 147456, v5
    v_lshlrev_b32 v6, 4, v1
    s_lshl_b32 s29, s27, 2
    s_setprio 2
    s_lshl_b32 s53, s59, 7
    v_lshlrev_b32 v4, 2, v9
    v_add_u32 v4, s53, v4
    v_add_u32 v4, 148480, v4
    ds_read_b32 v10, v4
    ds_read_b32 v11, v4 offset:512
    s_lshl_b32 s53, s59, 7
    v_lshlrev_b32 v7, 4, v8
    v_add_u32 v7, s53, v7
    v_add_u32 v7, 148480, v7
    ds_read_b128 v[120:123], v7 offset:0
    ds_read_b128 v[136:139], v7 offset:512
    ds_read_b128 v[124:127], v7 offset:32
    ds_read_b128 v[140:143], v7 offset:544
    ds_read_b128 v[128:131], v7 offset:64
    ds_read_b128 v[144:147], v7 offset:576
    ds_read_b128 v[132:135], v7 offset:96
    ds_read_b128 v[148:151], v7 offset:608
    v_lshrrev_b32 v12, 4, v9
    v_lshlrev_b32 v12, 16, v12
    v_lshl_add_u32 v12, v8, 8, v12
    v_and_b32 v13, 15, v9
    v_lshl_add_u32 v12, v13, 4, v12
    s_add_u32 s70, s29, s59
    s_lshl_b32 s71, s43, 7
    v_lshlrev_b32 v13, 2, v9
    v_add_u32 v13, s71, v13
    v_add_u32 v13, 147968, v13
    ds_read_b32 v16, v13
    s_lshl_b32 s71, s52, 7
    v_lshlrev_b32 v13, 2, v9
    v_add_u32 v13, s71, v13
    v_add_u32 v13, 147968, v13
    ds_read_b32 v17, v13
    s_waitcnt lgkmcnt(8)
    s_lshl_b32 s71, s42, 7
    v_lshlrev_b32 v13, 2, v9
    v_add_u32 v13, s71, v13
    v_add_u32 v13, 147968, v13
    ds_read_b32 v18, v13
    s_waitcnt lgkmcnt(0)
    s_add_u32 s54, s58, s43
    s_lshl_b32 s53, s54, 17
    s_lshl_b32 s55, s70, 10
    s_add_u32 s53, s53, s55
    v_mul_f32 v80, v16, v136
    v_mul_f32 v81, v16, v137
    v_mul_f32 v82, v16, v138
    v_mul_f32 v83, v16, v139
    v_mul_f32 v84, v16, v140
    v_mul_f32 v85, v16, v141
    v_mul_f32 v86, v16, v142
    v_mul_f32 v87, v16, v143
    v_mul_f32 v88, v16, v144
    v_mul_f32 v89, v16, v145
    v_mul_f32 v90, v16, v146
    v_mul_f32 v91, v16, v147
    v_mul_f32 v92, v16, v148
    v_mul_f32 v93, v16, v149
    v_mul_f32 v94, v16, v150
    v_mul_f32 v95, v16, v151
    v_fma_f32 v32, v32, v120, -v80
    v_fma_f32 v33, v33, v121, -v81
    v_fma_f32 v34, v34, v122, -v82
    v_fma_f32 v35, v35, v123, -v83
    v_fma_f32 v36, v36, v124, -v84
    v_fma_f32 v37, v37, v125, -v85
    v_fma_f32 v38, v38, v126, -v86
    v_fma_f32 v39, v39, v127, -v87
    v_fma_f32 v40, v40, v128, -v88
    v_fma_f32 v41, v41, v129, -v89
    v_fma_f32 v42, v42, v130, -v90
    v_fma_f32 v43, v43, v131, -v91
    v_fma_f32 v44, v44, v132, -v92
    v_fma_f32 v45, v45, v133, -v93
    v_fma_f32 v46, v46, v134, -v94
    v_fma_f32 v47, v47, v135, -v95
    v_cvt_pk_bf16_f32 v112, v32, v33
    v_cvt_pk_bf16_f32 v113, v34, v35
    v_cvt_pk_bf16_f32 v114, v36, v37
    v_cvt_pk_bf16_f32 v115, v38, v39
    v_cvt_pk_bf16_f32 v116, v40, v41
    v_cvt_pk_bf16_f32 v117, v42, v43
    v_cvt_pk_bf16_f32 v118, v44, v45
    v_cvt_pk_bf16_f32 v119, v46, v47
    buffer_store_dwordx4 v[112:115], v12, s[12:15], s53 offen sc1
    buffer_store_dwordx4 v[116:119], v12, s[12:15], s53 offen offset:512 sc1
    s_nop 1
    s_add_u32 s54, s58, s52
    s_lshl_b32 s53, s54, 17
    s_lshl_b32 s55, s70, 10
    s_add_u32 s53, s53, s55
    v_mul_f32 v80, v17, v136
    v_mul_f32 v81, v17, v137
    v_mul_f32 v82, v17, v138
    v_mul_f32 v83, v17, v139
    v_mul_f32 v84, v17, v140
    v_mul_f32 v85, v17, v141
    v_mul_f32 v86, v17, v142
    v_mul_f32 v87, v17, v143
    v_mul_f32 v88, v17, v144
    v_mul_f32 v89, v17, v145
    v_mul_f32 v90, v17, v146
    v_mul_f32 v91, v17, v147
    v_mul_f32 v92, v17, v148
    v_mul_f32 v93, v17, v149
    v_mul_f32 v94, v17, v150
    v_mul_f32 v95, v17, v151
    v_fma_f32 v48, v48, v120, -v80
    v_fma_f32 v49, v49, v121, -v81
    v_fma_f32 v50, v50, v122, -v82
    v_fma_f32 v51, v51, v123, -v83
    v_fma_f32 v52, v52, v124, -v84
    v_fma_f32 v53, v53, v125, -v85
    v_fma_f32 v54, v54, v126, -v86
    v_fma_f32 v55, v55, v127, -v87
    v_fma_f32 v56, v56, v128, -v88
    v_fma_f32 v57, v57, v129, -v89
    v_fma_f32 v58, v58, v130, -v90
    v_fma_f32 v59, v59, v131, -v91
    v_fma_f32 v60, v60, v132, -v92
    v_fma_f32 v61, v61, v133, -v93
    v_fma_f32 v62, v62, v134, -v94
    v_fma_f32 v63, v63, v135, -v95
    v_cvt_pk_bf16_f32 v112, v48, v49
    v_cvt_pk_bf16_f32 v113, v50, v51
    v_cvt_pk_bf16_f32 v114, v52, v53
    v_cvt_pk_bf16_f32 v115, v54, v55
    v_cvt_pk_bf16_f32 v116, v56, v57
    v_cvt_pk_bf16_f32 v117, v58, v59
    v_cvt_pk_bf16_f32 v118, v60, v61
    v_cvt_pk_bf16_f32 v119, v62, v63
    buffer_store_dwordx4 v[112:115], v12, s[12:15], s53 offen sc1
    buffer_store_dwordx4 v[116:119], v12, s[12:15], s53 offen offset:512 sc1
    s_nop 1
    s_add_u32 s54, s58, s42
    s_lshl_b32 s53, s54, 17
    s_lshl_b32 s55, s70, 10
    s_add_u32 s53, s53, s55
    v_mul_f32 v80, v18, v136
    v_mul_f32 v81, v18, v137
    v_mul_f32 v82, v18, v138
    v_mul_f32 v83, v18, v139
    v_mul_f32 v84, v18, v140
    v_mul_f32 v85, v18, v141
    v_mul_f32 v86, v18, v142
    v_mul_f32 v87, v18, v143
    v_mul_f32 v88, v18, v144
    v_mul_f32 v89, v18, v145
    v_mul_f32 v90, v18, v146
    v_mul_f32 v91, v18, v147
    v_mul_f32 v92, v18, v148
    v_mul_f32 v93, v18, v149
    v_mul_f32 v94, v18, v150
    v_mul_f32 v95, v18, v151
    v_fma_f32 v64, v64, v120, -v80
    v_fma_f32 v65, v65, v121, -v81
    v_fma_f32 v66, v66, v122, -v82
    v_fma_f32 v67, v67, v123, -v83
    v_fma_f32 v68, v68, v124, -v84
    v_fma_f32 v69, v69, v125, -v85
    v_fma_f32 v70, v70, v126, -v86
    v_fma_f32 v71, v71, v127, -v87
    v_fma_f32 v72, v72, v128, -v88
    v_fma_f32 v73, v73, v129, -v89
    v_fma_f32 v74, v74, v130, -v90
    v_fma_f32 v75, v75, v131, -v91
    v_fma_f32 v76, v76, v132, -v92
    v_fma_f32 v77, v77, v133, -v93
    v_fma_f32 v78, v78, v134, -v94
    v_fma_f32 v79, v79, v135, -v95
    v_cvt_pk_bf16_f32 v112, v64, v65
    v_cvt_pk_bf16_f32 v113, v66, v67
    v_cvt_pk_bf16_f32 v114, v68, v69
    v_cvt_pk_bf16_f32 v115, v70, v71
    v_cvt_pk_bf16_f32 v116, v72, v73
    v_cvt_pk_bf16_f32 v117, v74, v75
    v_cvt_pk_bf16_f32 v118, v76, v77
    v_cvt_pk_bf16_f32 v119, v78, v79
    buffer_store_dwordx4 v[112:115], v12, s[12:15], s53 offen sc1
    buffer_store_dwordx4 v[116:119], v12, s[12:15], s53 offen offset:512 sc1
    s_nop 1
    s_endpgm
k1_kernel_prod1:
    v_lshrrev_b32 v2, 3, v1
    v_and_b32 v3, 7, v1
    v_lshrrev_b32 v4, 4, v1
    v_xor_b32 v5, v3, v4
    v_lshlrev_b32 v5, 4, v5
    v_lshl_add_u32 v10, v2, 10, v5
    v_xor_b32 v11, 64, v10
    v_add_u32 v11, 0x2000, v11
    v_and_b32 v3, 3, v1
    v_bfe_u32 v5, v1, 2, 2
    v_xor_b32 v5, v5, v4
    v_lshlrev_b32 v6, 4, v3
    v_lshl_add_u32 v6, v5, 6, v6
    v_mul_u32_u24 v7, 3584, v4
    v_add_u32 v12, v7, v6
    v_mul_u32_u24 v7, 3072, v4
    v_add_u32 v13, v7, v6
    v_mov_b32 v7, 0x7f000000
    v_cmp_eq_u32 vcc, 3, v5
    v_cmp_le_u32 s[72:73], s69, v5
    s_nop 1
    v_cndmask_b32 v13, v13, v7, vcc
    v_cndmask_b32 v12, v12, v7, s[72:73]
    s_lshl_b32 s32, s27, 17
    s_lshl_b32 s53, s25, 15
    s_add_u32 s32, s32, s53
    s_mul_i32 s33, s25, 28672
    s_lshl_b32 s53, s57, 6
    s_add_u32 s33, s33, s53
    s_mul_i32 s34, s25, 24576
    s_lshl_b32 s53, s58, 6
    s_add_u32 s34, s34, s53
    s_lshl_b32 s30, s25, 12
    s_lshl_b32 s31, s25, 11
    s_add_u32 s31, s31, 49152
    s_waitcnt lgkmcnt(0)
    s_mov_b32 s4, s36
    s_and_b32 s5, s37, 0xffff
    s_mov_b32 s6, 0x200000
    s_mov_b32 s7, 0x20000
    s_mov_b32 s8, s44
    s_and_b32 s9, s45, 0xffff
    s_mov_b32 s10, 0x1c0000
    s_mov_b32 s11, 0x20000
    s_mov_b32 s64, s38
    s_and_b32 s65, s39, 0xffff
    s_mov_b32 s66, 0x180000
    s_mov_b32 s67, 0x20000
    s_mov_b32 m0, s30
    s_add_u32 s53, s32, 16384
    buffer_load_dwordx4 v10, s[4:7], s32 offen lds
    s_add_u32 m0, s30, 1024
    s_nop 0
    buffer_load_dwordx4 v11, s[4:7], s32 offen lds
    s_add_u32 m0, s30, 2048
    s_add_u32 s32, s32, 128
    buffer_load_dwordx4 v10, s[4:7], s53 offen lds
    s_add_u32 m0, s30, 3072
    s_add_u32 s30, s30, 16384
    buffer_load_dwordx4 v11, s[4:7], s53 offen lds
    s_cmp_ge_u32 s30, 49152
    s_cselect_b32 s53, 49152, 0
    s_sub_u32 s30, s30, s53
    s_mov_b32 m0, s31
    s_add_u32 s55, s33, 14336
    buffer_load_dwordx4 v12, s[8:11], s33 offen lds
    s_add_u32 m0, s31, 1024
    s_add_u32 s33, s33, 114688
    buffer_load_dwordx4 v12, s[8:11], s55 offen lds
    s_add_u32 m0, s31, 8192
    s_add_u32 s55, s34, 12288
    buffer_load_dwordx4 v13, s[64:67], s34 offen lds
    s_add_u32 m0, s31, 9216
    s_add_u32 s34, s34, 98304
    buffer_load_dwordx4 v13, s[64:67], s55 offen lds
    s_add_u32 s31, s31, 16384
    s_cmp_ge_u32 s31, 147456
    s_cselect_b32 s55, 98304, 0
    s_sub_u32 s31, s31, s55
    s_mov_b32 m0, s31
    s_add_u32 s55, s33, 14336
    buffer_load_dwordx4 v12, s[8:11], s33 offen lds
    s_add_u32 m0, s31, 1024
    s_add_u32 s33, s33, 114688
    buffer_load_dwordx4 v12, s[8:11], s55 offen lds
    s_add_u32 m0, s31, 8192
    s_add_u32 s55, s34, 12288
    buffer_load_dwordx4 v13, s[64:67], s34 offen lds
    s_add_u32 m0, s31, 9216
    s_add_u32 s34, s34, 98304
    buffer_load_dwordx4 v13, s[64:67], s55 offen lds
    s_add_u32 s31, s31, 16384
    s_cmp_ge_u32 s31, 147456
    s_cselect_b32 s55, 98304, 0
    s_sub_u32 s31, s31, s55
    s_mov_b32 m0, s30
    s_add_u32 s53, s32, 16384
    buffer_load_dwordx4 v10, s[4:7], s32 offen lds
    s_add_u32 m0, s30, 1024
    s_nop 0
    buffer_load_dwordx4 v11, s[4:7], s32 offen lds
    s_add_u32 m0, s30, 2048
    s_add_u32 s32, s32, 128
    buffer_load_dwordx4 v10, s[4:7], s53 offen lds
    s_add_u32 m0, s30, 3072
    s_add_u32 s30, s30, 16384
    buffer_load_dwordx4 v11, s[4:7], s53 offen lds
    s_cmp_ge_u32 s30, 49152
    s_cselect_b32 s53, 49152, 0
    s_sub_u32 s30, s30, s53
    s_mov_b32 m0, s31
    s_add_u32 s55, s33, 14336
    buffer_load_dwordx4 v12, s[8:11], s33 offen lds
    s_add_u32 m0, s31, 1024
    s_add_u32 s33, s33, 114688
    buffer_load_dwordx4 v12, s[8:11], s55 offen lds
    s_add_u32 m0, s31, 8192
    s_add_u32 s55, s34, 12288
    buffer_load_dwordx4 v13, s[64:67], s34 offen lds
    s_add_u32 m0, s31, 9216
    s_add_u32 s34, s34, 98304
    buffer_load_dwordx4 v13, s[64:67], s55 offen lds
    s_add_u32 s31, s31, 16384
    s_cmp_ge_u32 s31, 147456
    s_cselect_b32 s55, 98304, 0
    s_sub_u32 s31, s31, s55
    v_bfe_u32 v2, v9, 1, 3
    v_xor_b32 v2, v2, v8
    v_lshlrev_b32 v2, 4, v2
    v_lshl_add_u32 v4, v9, 7, v2
    s_lshl_b32 s53, s25, 12
    v_add_u32 v14, s53, v4
    v_xor_b32 v15, 32, v14
    v_xor_b32 v16, 64, v14
    v_xor_b32 v17, 96, v14
    v_mov_b32 v36, 0
    v_mov_b32 v37, 0
    v_mov_b32 v38, 0
    v_mov_b32 v39, 0
    s_mov_b32 s56, 0
    s_mov_b32 s12, s50
    s_and_b32 s13, s51, 0xffff
    s_mov_b32 s14, 0x10000000
    s_mov_b32 s15, 0x20000
    s_waitcnt vmcnt(12)
    s_barrier
    s_mov_b32 m0, s31
    s_add_u32 s55, s33, 14336
    buffer_load_dwordx4 v12, s[8:11], s33 offen lds
    s_add_u32 m0, s31, 1024
    s_add_u32 s33, s33, 114688
    buffer_load_dwordx4 v12, s[8:11], s55 offen lds
    s_add_u32 m0, s31, 8192
    s_add_u32 s55, s34, 12288
    buffer_load_dwordx4 v13, s[64:67], s34 offen lds
    s_add_u32 m0, s31, 9216
    s_add_u32 s34, s34, 98304
    buffer_load_dwordx4 v13, s[64:67], s55 offen lds
    s_add_u32 s31, s31, 16384
    s_cmp_ge_u32 s31, 147456
    s_cselect_b32 s55, 98304, 0
    s_sub_u32 s31, s31, s55
    s_mov_b32 m0, s31
    s_add_u32 s55, s33, 14336
    buffer_load_dwordx4 v12, s[8:11], s33 offen lds
    s_add_u32 m0, s31, 1024
    s_add_u32 s33, s33, 114688
    buffer_load_dwordx4 v12, s[8:11], s55 offen lds
    s_add_u32 m0, s31, 8192
    s_add_u32 s55, s34, 12288
    buffer_load_dwordx4 v13, s[64:67], s34 offen lds
    s_add_u32 m0, s31, 9216
    s_add_u32 s34, s34, 98304
    buffer_load_dwordx4 v13, s[64:67], s55 offen lds
    s_add_u32 s31, s31, 16384
    s_cmp_ge_u32 s31, 147456
    s_cselect_b32 s55, 98304, 0
    s_sub_u32 s31, s31, s55
    s_waitcnt vmcnt(16)
    s_barrier
    ds_read_b128 v[20:23], v14
    ds_read_b128 v[24:27], v15
    s_mov_b32 m0, s30
    s_add_u32 s53, s32, 16384
    buffer_load_dwordx4 v10, s[4:7], s32 offen lds
    s_add_u32 m0, s30, 1024
    s_nop 0
    buffer_load_dwordx4 v11, s[4:7], s32 offen lds
    s_add_u32 m0, s30, 2048
    s_add_u32 s32, s32, 128
    buffer_load_dwordx4 v10, s[4:7], s53 offen lds
    s_add_u32 m0, s30, 3072
    s_add_u32 s30, s30, 16384
    buffer_load_dwordx4 v11, s[4:7], s53 offen lds
    s_cmp_ge_u32 s30, 49152
    s_cselect_b32 s53, 49152, 0
    s_sub_u32 s30, s30, s53
    s_mov_b32 m0, s31
    s_add_u32 s55, s33, 14336
    buffer_load_dwordx4 v12, s[8:11], s33 offen lds
    s_add_u32 m0, s31, 1024
    s_add_u32 s33, s33, 114688
    buffer_load_dwordx4 v12, s[8:11], s55 offen lds
    s_add_u32 m0, s31, 8192
    s_add_u32 s55, s34, 12288
    buffer_load_dwordx4 v13, s[64:67], s34 offen lds
    s_add_u32 m0, s31, 9216
    s_add_u32 s34, s34, 98304
    buffer_load_dwordx4 v13, s[64:67], s55 offen lds
    s_add_u32 s31, s31, 16384
    s_cmp_ge_u32 s31, 147456
    s_cselect_b32 s55, 98304, 0
    s_sub_u32 s31, s31, s55
    s_waitcnt lgkmcnt(0)
    s_mov_b32 s29, 0
k1_kernel_ploop15:
    s_waitcnt vmcnt(16)
    s_barrier
    ds_read_b128 v[72:75], v16
    ds_read_b128 v[76:79], v17
    s_add_u32 s56, s56, 16384
    s_cmp_eq_u32 s56, 49152
    s_mov_b32 s54, 16384
    s_cselect_b32 s54, 0xffff8000, s54
    s_cselect_b32 s56, 0, s56
    v_add_u32 v14, s54, v14
    v_add_u32 v15, s54, v15
    v_add_u32 v16, s54, v16
    v_add_u32 v17, s54, v17
    s_mov_b32 m0, s31
    s_add_u32 s55, s33, 14336
    buffer_load_dwordx4 v12, s[8:11], s33 offen lds
    v_and_b32 v28, 0xffff0000, v20
    v_lshlrev_b32 v29, 16, v20
    v_and_b32 v30, 0xffff0000, v21
    v_lshlrev_b32 v31, 16, v21
    v_and_b32 v32, 0xffff0000, v22
    v_lshlrev_b32 v33, 16, v22
    v_and_b32 v34, 0xffff0000, v23
    v_lshlrev_b32 v35, 16, v23
    v_add_f32 v36, v36, v28
    v_fmac_f32 v38, v28, v28
    v_add_f32 v37, v37, v29
    v_fmac_f32 v39, v29, v29
    s_add_u32 m0, s31, 1024
    s_add_u32 s33, s33, 114688
    buffer_load_dwordx4 v12, s[8:11], s55 offen lds
    v_add_f32 v36, v36, v30
    v_fmac_f32 v38, v30, v30
    v_add_f32 v37, v37, v31
    v_fmac_f32 v39, v31, v31
    v_add_f32 v36, v36, v32
    v_fmac_f32 v38, v32, v32
    v_add_f32 v37, v37, v33
    v_fmac_f32 v39, v33, v33
    v_add_f32 v36, v36, v34
    v_fmac_f32 v38, v34, v34
    v_add_f32 v37, v37, v35
    v_fmac_f32 v39, v35, v35
    s_add_u32 m0, s31, 8192
    s_add_u32 s55, s34, 12288
    buffer_load_dwordx4 v13, s[64:67], s34 offen lds
    v_and_b32 v28, 0xffff0000, v24
    v_lshlrev_b32 v29, 16, v24
    v_and_b32 v30, 0xffff0000, v25
    v_lshlrev_b32 v31, 16, v25
    v_and_b32 v32, 0xffff0000, v26
    v_lshlrev_b32 v33, 16, v26
    v_and_b32 v34, 0xffff0000, v27
    v_lshlrev_b32 v35, 16, v27
    v_add_f32 v36, v36, v28
    v_fmac_f32 v38, v28, v28
    v_add_f32 v37, v37, v29
    v_fmac_f32 v39, v29, v29
    s_add_u32 m0, s31, 9216
    s_add_u32 s34, s34, 98304
    buffer_load_dwordx4 v13, s[64:67], s55 offen lds
    s_add_u32 s31, s31, 16384
    s_cmp_ge_u32 s31, 147456
    s_cselect_b32 s55, 98304, 0
    s_sub_u32 s31, s31, s55
    v_add_f32 v36, v36, v30
    v_fmac_f32 v38, v30, v30
    v_add_f32 v37, v37, v31
    v_fmac_f32 v39, v31, v31
    v_add_f32 v36, v36, v32
    v_fmac_f32 v38, v32, v32
    v_add_f32 v37, v37, v33
    v_fmac_f32 v39, v33, v33
    v_add_f32 v36, v36, v34
    v_fmac_f32 v38, v34, v34
    v_add_f32 v37, v37, v35
    v_fmac_f32 v39, v35, v35
    s_waitcnt lgkmcnt(0)
    s_waitcnt vmcnt(16)
    s_barrier
    ds_read_b128 v[20:23], v14
    ds_read_b128 v[24:27], v15
    s_mov_b32 m0, s30
    s_add_u32 s53, s32, 16384
    buffer_load_dwordx4 v10, s[4:7], s32 offen lds
    v_and_b32 v28, 0xffff0000, v72
    v_lshlrev_b32 v29, 16, v72
    v_and_b32 v30, 0xffff0000, v73
    v_lshlrev_b32 v31, 16, v73
    v_and_b32 v32, 0xffff0000, v74
    v_lshlrev_b32 v33, 16, v74
    s_add_u32 m0, s30, 1024
    s_nop 0
    buffer_load_dwordx4 v11, s[4:7], s32 offen lds
    v_and_b32 v34, 0xffff0000, v75
    v_lshlrev_b32 v35, 16, v75
    v_add_f32 v36, v36, v28
    v_fmac_f32 v38, v28, v28
    v_add_f32 v37, v37, v29
    v_fmac_f32 v39, v29, v29
    s_add_u32 m0, s30, 2048
    s_add_u32 s32, s32, 128
    buffer_load_dwordx4 v10, s[4:7], s53 offen lds
    v_add_f32 v36, v36, v30
    v_fmac_f32 v38, v30, v30
    v_add_f32 v37, v37, v31
    v_fmac_f32 v39, v31, v31
    v_add_f32 v36, v36, v32
    v_fmac_f32 v38, v32, v32
    s_add_u32 m0, s30, 3072
    s_add_u32 s30, s30, 16384
    buffer_load_dwordx4 v11, s[4:7], s53 offen lds
    s_cmp_ge_u32 s30, 49152
    s_cselect_b32 s53, 49152, 0
    s_sub_u32 s30, s30, s53
    v_add_f32 v37, v37, v33
    v_fmac_f32 v39, v33, v33
    v_add_f32 v36, v36, v34
    v_fmac_f32 v38, v34, v34
    v_add_f32 v37, v37, v35
    v_fmac_f32 v39, v35, v35
    s_mov_b32 m0, s31
    s_add_u32 s55, s33, 14336
    buffer_load_dwordx4 v12, s[8:11], s33 offen lds
    v_and_b32 v28, 0xffff0000, v76
    v_lshlrev_b32 v29, 16, v76
    v_and_b32 v30, 0xffff0000, v77
    v_lshlrev_b32 v31, 16, v77
    v_and_b32 v32, 0xffff0000, v78
    v_lshlrev_b32 v33, 16, v78
    s_add_u32 m0, s31, 1024
    s_add_u32 s33, s33, 114688
    buffer_load_dwordx4 v12, s[8:11], s55 offen lds
    v_and_b32 v34, 0xffff0000, v79
    v_lshlrev_b32 v35, 16, v79
    v_add_f32 v36, v36, v28
    v_fmac_f32 v38, v28, v28
    v_add_f32 v37, v37, v29
    v_fmac_f32 v39, v29, v29
    s_add_u32 m0, s31, 8192
    s_add_u32 s55, s34, 12288
    buffer_load_dwordx4 v13, s[64:67], s34 offen lds
    v_add_f32 v36, v36, v30
    v_fmac_f32 v38, v30, v30
    v_add_f32 v37, v37, v31
    v_fmac_f32 v39, v31, v31
    v_add_f32 v36, v36, v32
    v_fmac_f32 v38, v32, v32
    s_add_u32 m0, s31, 9216
    s_add_u32 s34, s34, 98304
    buffer_load_dwordx4 v13, s[64:67], s55 offen lds
    s_add_u32 s31, s31, 16384
    s_cmp_ge_u32 s31, 147456
    s_cselect_b32 s55, 98304, 0
    s_sub_u32 s31, s31, s55
    v_add_f32 v37, v37, v33
    v_fmac_f32 v39, v33, v33
    v_add_f32 v36, v36, v34
    v_fmac_f32 v38, v34, v34
    v_add_f32 v37, v37, v35
    v_fmac_f32 v39, v35, v35
    s_waitcnt lgkmcnt(0)
    s_add_u32 s29, s29, 1
    s_cmp_lt_u32 s29, 5
    s_cbranch_scc1 k1_kernel_ploop15
    s_waitcnt vmcnt(16)
    s_barrier
    ds_read_b128 v[72:75], v16
    ds_read_b128 v[76:79], v17
    s_add_u32 s56, s56, 16384
    s_cmp_eq_u32 s56, 49152
    s_mov_b32 s54, 16384
    s_cselect_b32 s54, 0xffff8000, s54
    s_cselect_b32 s56, 0, s56
    v_add_u32 v14, s54, v14
    v_add_u32 v15, s54, v15
    v_add_u32 v16, s54, v16
    v_add_u32 v17, s54, v17
    v_and_b32 v28, 0xffff0000, v20
    v_lshlrev_b32 v29, 16, v20
    v_and_b32 v30, 0xffff0000, v21
    v_lshlrev_b32 v31, 16, v21
    v_and_b32 v32, 0xffff0000, v22
    v_lshlrev_b32 v33, 16, v22
    v_and_b32 v34, 0xffff0000, v23
    v_lshlrev_b32 v35, 16, v23
    v_add_f32 v36, v36, v28
    v_fmac_f32 v38, v28, v28
    v_add_f32 v37, v37, v29
    v_fmac_f32 v39, v29, v29
    v_add_f32 v36, v36, v30
    v_fmac_f32 v38, v30, v30
    v_add_f32 v37, v37, v31
    v_fmac_f32 v39, v31, v31
    v_add_f32 v36, v36, v32
    v_fmac_f32 v38, v32, v32
    v_add_f32 v37, v37, v33
    v_fmac_f32 v39, v33, v33
    v_add_f32 v36, v36, v34
    v_fmac_f32 v38, v34, v34
    v_add_f32 v37, v37, v35
    v_fmac_f32 v39, v35, v35
    v_and_b32 v28, 0xffff0000, v24
    v_lshlrev_b32 v29, 16, v24
    v_and_b32 v30, 0xffff0000, v25
    v_lshlrev_b32 v31, 16, v25
    v_and_b32 v32, 0xffff0000, v26
    v_lshlrev_b32 v33, 16, v26
    v_and_b32 v34, 0xffff0000, v27
    v_lshlrev_b32 v35, 16, v27
    v_add_f32 v36, v36, v28
    v_fmac_f32 v38, v28, v28
    v_add_f32 v37, v37, v29
    v_fmac_f32 v39, v29, v29
    v_add_f32 v36, v36, v30
    v_fmac_f32 v38, v30, v30
    v_add_f32 v37, v37, v31
    v_fmac_f32 v39, v31, v31
    v_add_f32 v36, v36, v32
    v_fmac_f32 v38, v32, v32
    v_add_f32 v37, v37, v33
    v_fmac_f32 v39, v33, v33
    v_add_f32 v36, v36, v34
    v_fmac_f32 v38, v34, v34
    v_add_f32 v37, v37, v35
    v_fmac_f32 v39, v35, v35
    s_waitcnt lgkmcnt(0)
    s_waitcnt vmcnt(12)
    s_barrier
    ds_read_b128 v[20:23], v14
    ds_read_b128 v[24:27], v15
    v_and_b32 v28, 0xffff0000, v72
    v_lshlrev_b32 v29, 16, v72
    v_and_b32 v30, 0xffff0000, v73
    v_lshlrev_b32 v31, 16, v73
    v_and_b32 v32, 0xffff0000, v74
    v_lshlrev_b32 v33, 16, v74
    v_and_b32 v34, 0xffff0000, v75
    v_lshlrev_b32 v35, 16, v75
    v_add_f32 v36, v36, v28
    v_fmac_f32 v38, v28, v28
    v_add_f32 v37, v37, v29
    v_fmac_f32 v39, v29, v29
    v_add_f32 v36, v36, v30
    v_fmac_f32 v38, v30, v30
    v_add_f32 v37, v37, v31
    v_fmac_f32 v39, v31, v31
    v_add_f32 v36, v36, v32
    v_fmac_f32 v38, v32, v32
    v_add_f32 v37, v37, v33
    v_fmac_f32 v39, v33, v33
    v_add_f32 v36, v36, v34
    v_fmac_f32 v38, v34, v34
    v_add_f32 v37, v37, v35
    v_fmac_f32 v39, v35, v35
    v_and_b32 v28, 0xffff0000, v76
    v_lshlrev_b32 v29, 16, v76
    v_and_b32 v30, 0xffff0000, v77
    v_lshlrev_b32 v31, 16, v77
    v_and_b32 v32, 0xffff0000, v78
    v_lshlrev_b32 v33, 16, v78
    v_and_b32 v34, 0xffff0000, v79
    v_lshlrev_b32 v35, 16, v79
    v_add_f32 v36, v36, v28
    v_fmac_f32 v38, v28, v28
    v_add_f32 v37, v37, v29
    v_fmac_f32 v39, v29, v29
    v_add_f32 v36, v36, v30
    v_fmac_f32 v38, v30, v30
    v_add_f32 v37, v37, v31
    v_fmac_f32 v39, v31, v31
    v_add_f32 v36, v36, v32
    v_fmac_f32 v38, v32, v32
    v_add_f32 v37, v37, v33
    v_fmac_f32 v39, v33, v33
    v_add_f32 v36, v36, v34
    v_fmac_f32 v38, v34, v34
    v_add_f32 v37, v37, v35
    v_fmac_f32 v39, v35, v35
    s_waitcnt lgkmcnt(0)
    s_waitcnt vmcnt(4)
    s_barrier
    ds_read_b128 v[72:75], v16
    ds_read_b128 v[76:79], v17
    s_add_u32 s56, s56, 16384
    s_cmp_eq_u32 s56, 49152
    s_mov_b32 s54, 16384
    s_cselect_b32 s54, 0xffff8000, s54
    s_cselect_b32 s56, 0, s56
    v_add_u32 v14, s54, v14
    v_add_u32 v15, s54, v15
    v_add_u32 v16, s54, v16
    v_add_u32 v17, s54, v17
    v_and_b32 v28, 0xffff0000, v20
    v_lshlrev_b32 v29, 16, v20
    v_and_b32 v30, 0xffff0000, v21
    v_lshlrev_b32 v31, 16, v21
    v_and_b32 v32, 0xffff0000, v22
    v_lshlrev_b32 v33, 16, v22
    v_and_b32 v34, 0xffff0000, v23
    v_lshlrev_b32 v35, 16, v23
    v_add_f32 v36, v36, v28
    v_fmac_f32 v38, v28, v28
    v_add_f32 v37, v37, v29
    v_fmac_f32 v39, v29, v29
    v_add_f32 v36, v36, v30
    v_fmac_f32 v38, v30, v30
    v_add_f32 v37, v37, v31
    v_fmac_f32 v39, v31, v31
    v_add_f32 v36, v36, v32
    v_fmac_f32 v38, v32, v32
    v_add_f32 v37, v37, v33
    v_fmac_f32 v39, v33, v33
    v_add_f32 v36, v36, v34
    v_fmac_f32 v38, v34, v34
    v_add_f32 v37, v37, v35
    v_fmac_f32 v39, v35, v35
    v_and_b32 v28, 0xffff0000, v24
    v_lshlrev_b32 v29, 16, v24
    v_and_b32 v30, 0xffff0000, v25
    v_lshlrev_b32 v31, 16, v25
    v_and_b32 v32, 0xffff0000, v26
    v_lshlrev_b32 v33, 16, v26
    v_and_b32 v34, 0xffff0000, v27
    v_lshlrev_b32 v35, 16, v27
    v_add_f32 v36, v36, v28
    v_fmac_f32 v38, v28, v28
    v_add_f32 v37, v37, v29
    v_fmac_f32 v39, v29, v29
    v_add_f32 v36, v36, v30
    v_fmac_f32 v38, v30, v30
    v_add_f32 v37, v37, v31
    v_fmac_f32 v39, v31, v31
    v_add_f32 v36, v36, v32
    v_fmac_f32 v38, v32, v32
    v_add_f32 v37, v37, v33
    v_fmac_f32 v39, v33, v33
    v_add_f32 v36, v36, v34
    v_fmac_f32 v38, v34, v34
    v_add_f32 v37, v37, v35
    v_fmac_f32 v39, v35, v35
    s_waitcnt lgkmcnt(0)
    s_waitcnt vmcnt(0)
    s_barrier
    ds_read_b128 v[20:23], v14
    ds_read_b128 v[24:27], v15
    v_and_b32 v28, 0xffff0000, v72
    v_lshlrev_b32 v29, 16, v72
    v_and_b32 v30, 0xffff0000, v73
    v_lshlrev_b32 v31, 16, v73
    v_and_b32 v32, 0xffff0000, v74
    v_lshlrev_b32 v33, 16, v74
    v_and_b32 v34, 0xffff0000, v75
    v_lshlrev_b32 v35, 16, v75
    v_add_f32 v36, v36, v28
    v_fmac_f32 v38, v28, v28
    v_add_f32 v37, v37, v29
    v_fmac_f32 v39, v29, v29
    v_add_f32 v36, v36, v30
    v_fmac_f32 v38, v30, v30
    v_add_f32 v37, v37, v31
    v_fmac_f32 v39, v31, v31
    v_add_f32 v36, v36, v32
    v_fmac_f32 v38, v32, v32
    v_add_f32 v37, v37, v33
    v_fmac_f32 v39, v33, v33
    v_add_f32 v36, v36, v34
    v_fmac_f32 v38, v34, v34
    v_add_f32 v37, v37, v35
    v_fmac_f32 v39, v35, v35
    v_and_b32 v28, 0xffff0000, v76
    v_lshlrev_b32 v29, 16, v76
    v_and_b32 v30, 0xffff0000, v77
    v_lshlrev_b32 v31, 16, v77
    v_and_b32 v32, 0xffff0000, v78
    v_lshlrev_b32 v33, 16, v78
    v_and_b32 v34, 0xffff0000, v79
    v_lshlrev_b32 v35, 16, v79
    v_add_f32 v36, v36, v28
    v_fmac_f32 v38, v28, v28
    v_add_f32 v37, v37, v29
    v_fmac_f32 v39, v29, v29
    v_add_f32 v36, v36, v30
    v_fmac_f32 v38, v30, v30
    v_add_f32 v37, v37, v31
    v_fmac_f32 v39, v31, v31
    v_add_f32 v36, v36, v32
    v_fmac_f32 v38, v32, v32
    v_add_f32 v37, v37, v33
    v_fmac_f32 v39, v33, v33
    v_add_f32 v36, v36, v34
    v_fmac_f32 v38, v34, v34
    v_add_f32 v37, v37, v35
    v_fmac_f32 v39, v35, v35
    v_lshlrev_b32 v2, 12, v8
    v_lshl_add_u32 v64, v9, 1, v2
    v_add_u32 v65, 0x2000, v64
    s_and_b32 s55, s2, 3
    s_lshl_b32 s55, s55, 2
    s_add_u32 s55, s55, s25
    s_lshr_b32 s53, s2, 2
    s_cmp_lt_u32 s53, 32
    s_cselect_b32 s16, s40, s48
    s_cselect_b32 s17, s41, s49
    s_mov_b32 s18, 0x1c0000
    s_cselect_b32 s18, 0x80000, s18
    s_cselect_b32 s54, 0, 32
    s_and_b32 s17, s17, 0xffff
    s_mov_b32 s19, 0x20000
    s_sub_u32 s54, s53, s54
    s_lshl_b32 s54, s54, 14
    s_lshl_b32 s60, s55, 6
    s_add_u32 s54, s54, s60
    buffer_load_ushort v40, v64, s[16:19], s54 offen offset:0
    buffer_load_ushort v41, v64, s[16:19], s54 offen offset:1024
    buffer_load_ushort v42, v64, s[16:19], s54 offen offset:2048
    buffer_load_ushort v43, v64, s[16:19], s54 offen offset:3072
    buffer_load_ushort v44, v65, s[16:19], s54 offen offset:0
    buffer_load_ushort v45, v65, s[16:19], s54 offen offset:1024
    buffer_load_ushort v46, v65, s[16:19], s54 offen offset:2048
    buffer_load_ushort v47, v65, s[16:19], s54 offen offset:3072
    s_lshl_b32 s60, s53, 4
    s_add_u32 s60, s60, s55
    s_lshl_b32 s60, s60, 10
    s_add_u32 s60, s60, 0xf00000
    s_lshr_b32 s53, s2, 2
    s_add_u32 s53, s53, 64
    s_mov_b32 s16, s48
    s_and_b32 s17, s49, 0xffff
    s_mov_b32 s18, 0x1c0000
    s_mov_b32 s19, 0x20000
    s_sub_u32 s54, s53, 32
    s_lshl_b32 s54, s54, 14
    s_lshl_b32 s61, s55, 6
    s_add_u32 s54, s54, s61
    buffer_load_ushort v48, v64, s[16:19], s54 offen offset:0
    buffer_load_ushort v49, v64, s[16:19], s54 offen offset:1024
    buffer_load_ushort v50, v64, s[16:19], s54 offen offset:2048
    buffer_load_ushort v51, v64, s[16:19], s54 offen offset:3072
    buffer_load_ushort v52, v65, s[16:19], s54 offen offset:0
    buffer_load_ushort v53, v65, s[16:19], s54 offen offset:1024
    buffer_load_ushort v54, v65, s[16:19], s54 offen offset:2048
    buffer_load_ushort v55, v65, s[16:19], s54 offen offset:3072
    s_lshl_b32 s61, s53, 4
    s_add_u32 s61, s61, s55
    s_lshl_b32 s61, s61, 10
    s_add_u32 s61, s61, 0xf00000
    s_cmp_ge_u32 s2, 64
    s_cbranch_scc1 k1_kernel_noswz316
    s_lshr_b32 s53, s2, 2
    s_add_u32 s53, s53, 128
    s_sub_u32 s54, s53, 32
    s_lshl_b32 s54, s54, 14
    s_lshl_b32 s62, s55, 6
    s_add_u32 s54, s54, s62
    buffer_load_ushort v56, v64, s[16:19], s54 offen offset:0
    buffer_load_ushort v57, v64, s[16:19], s54 offen offset:1024
    buffer_load_ushort v58, v64, s[16:19], s54 offen offset:2048
    buffer_load_ushort v59, v64, s[16:19], s54 offen offset:3072
    buffer_load_ushort v60, v65, s[16:19], s54 offen offset:0
    buffer_load_ushort v61, v65, s[16:19], s54 offen offset:1024
    buffer_load_ushort v62, v65, s[16:19], s54 offen offset:2048
    buffer_load_ushort v63, v65, s[16:19], s54 offen offset:3072
    s_lshl_b32 s62, s53, 4
    s_add_u32 s62, s62, s55
    s_lshl_b32 s62, s62, 10
    s_add_u32 s62, s62, 0xf00000
k1_kernel_noswz316:
    s_waitcnt lgkmcnt(0)
    s_barrier
    ds_read_b128 v[72:75], v16
    ds_read_b128 v[76:79], v17
    s_add_u32 s56, s56, 16384
    s_cmp_eq_u32 s56, 49152
    s_mov_b32 s54, 16384
    s_cselect_b32 s54, 0xffff8000, s54
    s_cselect_b32 s56, 0, s56
    v_add_u32 v14, s54, v14
    v_add_u32 v15, s54, v15
    v_add_u32 v16, s54, v16
    v_add_u32 v17, s54, v17
    v_and_b32 v28, 0xffff0000, v20
    v_lshlrev_b32 v29, 16, v20
    v_and_b32 v30, 0xffff0000, v21
    v_lshlrev_b32 v31, 16, v21
    v_and_b32 v32, 0xffff0000, v22
    v_lshlrev_b32 v33, 16, v22
    v_and_b32 v34, 0xffff0000, v23
    v_lshlrev_b32 v35, 16, v23
    v_add_f32 v36, v36, v28
    v_fmac_f32 v38, v28, v28
    v_add_f32 v37, v37, v29
    v_fmac_f32 v39, v29, v29
    v_add_f32 v36, v36, v30
    v_fmac_f32 v38, v30, v30
    v_add_f32 v37, v37, v31
    v_fmac_f32 v39, v31, v31
    v_add_f32 v36, v36, v32
    v_fmac_f32 v38, v32, v32
    v_add_f32 v37, v37, v33
    v_fmac_f32 v39, v33, v33
    v_add_f32 v36, v36, v34
    v_fmac_f32 v38, v34, v34
    v_add_f32 v37, v37, v35
    v_fmac_f32 v39, v35, v35
    v_and_b32 v28, 0xffff0000, v24
    v_lshlrev_b32 v29, 16, v24
    v_and_b32 v30, 0xffff0000, v25
    v_lshlrev_b32 v31, 16, v25
    v_and_b32 v32, 0xffff0000, v26
    v_lshlrev_b32 v33, 16, v26
    v_and_b32 v34, 0xffff0000, v27
    v_lshlrev_b32 v35, 16, v27
    v_add_f32 v36, v36, v28
    v_fmac_f32 v38, v28, v28
    v_add_f32 v37, v37, v29
    v_fmac_f32 v39, v29, v29
    v_add_f32 v36, v36, v30
    v_fmac_f32 v38, v30, v30
    v_add_f32 v37, v37, v31
    v_fmac_f32 v39, v31, v31
    v_add_f32 v36, v36, v32
    v_fmac_f32 v38, v32, v32
    v_add_f32 v37, v37, v33
    v_fmac_f32 v39, v33, v33
    v_add_f32 v36, v36, v34
    v_fmac_f32 v38, v34, v34
    v_add_f32 v37, v37, v35
    v_fmac_f32 v39, v35, v35
    s_waitcnt lgkmcnt(0)
    v_and_b32 v28, 0xffff0000, v72
    v_lshlrev_b32 v29, 16, v72
    v_and_b32 v30, 0xffff0000, v73
    v_lshlrev_b32 v31, 16, v73
    v_and_b32 v32, 0xffff0000, v74
    v_lshlrev_b32 v33, 16, v74
    v_and_b32 v34, 0xffff0000, v75
    v_lshlrev_b32 v35, 16, v75
    v_add_f32 v36, v36, v28
    v_fmac_f32 v38, v28, v28
    v_add_f32 v37, v37, v29
    v_fmac_f32 v39, v29, v29
    v_add_f32 v36, v36, v30
    v_fmac_f32 v38, v30, v30
    v_add_f32 v37, v37, v31
    v_fmac_f32 v39, v31, v31
    v_add_f32 v36, v36, v32
    v_fmac_f32 v38, v32, v32
    v_add_f32 v37, v37, v33
    v_fmac_f32 v39, v33, v33
    v_add_f32 v36, v36, v34
    v_fmac_f32 v38, v34, v34
    v_add_f32 v37, v37, v35
    v_fmac_f32 v39, v35, v35
    v_and_b32 v28, 0xffff0000, v76
    v_lshlrev_b32 v29, 16, v76
    v_and_b32 v30, 0xffff0000, v77
    v_lshlrev_b32 v31, 16, v77
    v_and_b32 v32, 0xffff0000, v78
    v_lshlrev_b32 v33, 16, v78
    v_and_b32 v34, 0xffff0000, v79
    v_lshlrev_b32 v35, 16, v79
    v_add_f32 v36, v36, v28
    v_fmac_f32 v38, v28, v28
    v_add_f32 v37, v37, v29
    v_fmac_f32 v39, v29, v29
    v_add_f32 v36, v36, v30
    v_fmac_f32 v38, v30, v30
    v_add_f32 v37, v37, v31
    v_fmac_f32 v39, v31, v31
    v_add_f32 v36, v36, v32
    v_fmac_f32 v38, v32, v32
    v_add_f32 v37, v37, v33
    v_fmac_f32 v39, v33, v33
    v_add_f32 v36, v36, v34
    v_fmac_f32 v38, v34, v34
    v_add_f32 v37, v37, v35
    v_fmac_f32 v39, v35, v35
    v_add_f32 v36, v36, v37
    v_add_f32 v38, v38, v39
    v_mov_b32 v37, v36
    v_mov_b32 v39, v38
    s_nop 1
    v_permlane32_swap_b32 v36, v37
    v_permlane32_swap_b32 v38, v39
    s_nop 1
    v_add_f32 v5, v36, v37
    v_add_f32 v6, v38, v39
    v_mul_f32 v5, 0x3b000000, v5
    v_mul_f32 v6, 0x3b000000, v6
    v_fma_f32 v6, -v5, v5, v6
    v_max_f32 v6, 0, v6
    v_cvt_pk_bf16_f32 v5, v5, v5
    v_lshlrev_b32 v5, 16, v5
    v_cvt_pk_bf16_f32 v6, v6, v6
    v_lshlrev_b32 v6, 16, v6
    v_add_f32 v6, 0x3727c5ac, v6
    v_cvt_pk_bf16_f32 v6, v6, v6
    v_lshlrev_b32 v6, 16, v6
    v_sqrt_f32 v6, v6
    s_nop 0
    v_cvt_pk_bf16_f32 v6, v6, v6
    v_lshlrev_b32 v6, 16, v6
    v_rcp_f32 v6, v6
    s_nop 0
    v_mul_f32 v5, v5, v6
    s_lshl_b32 s53, s25, 7
    v_lshlrev_b32 v2, 2, v9
    v_add_u32 v2, s53, v2
    v_add_u32 v2, 148480, v2
    ds_write_b32 v2, v6
    ds_write_b32 v2, v5 offset:512
    s_waitcnt lgkmcnt(0)
    s_barrier
    s_lshr_b32 s53, s25, 1
    s_and_b32 s54, s25, 1
    s_lshl_b32 s59, s53, 1
    s_or_b32 s59, s59, s54
    s_xor_b32 s42, s59, 1
    s_lshl_b32 s43, s54, 1
    s_or_b32 s43, s43, s53
    s_xor_b32 s52, s43, 1
    s_lshl_b32 s53, s53, 15
    s_lshl_b32 s54, s54, 13
    s_add_u32 s53, s53, s54
    v_lshlrev_b32 v6, 4, v1
    v_add_u32 v3, s53, v6
    s_waitcnt vmcnt(0)
    v_lshlrev_b32 v2, 4, v1
    v_lshl_or_b32 v68, v41, 16, v40
    v_lshl_or_b32 v69, v43, 16, v42
    v_lshl_or_b32 v70, v45, 16, v44
    v_lshl_or_b32 v71, v47, 16, v46
    buffer_store_dwordx4 v[68:71], v2, s[12:15], s60 offen sc1
    s_nop 1
    v_lshl_or_b32 v68, v49, 16, v48
    v_lshl_or_b32 v69, v51, 16, v50
    v_lshl_or_b32 v70, v53, 16, v52
    v_lshl_or_b32 v71, v55, 16, v54
    buffer_store_dwordx4 v[68:71], v2, s[12:15], s61 offen sc1
    s_nop 1
    s_cmp_ge_u32 s2, 64
    s_cbranch_scc1 k1_kernel_noswz3s17
    v_lshl_or_b32 v68, v57, 16, v56
    v_lshl_or_b32 v69, v59, 16, v58
    v_lshl_or_b32 v70, v61, 16, v60
    v_lshl_or_b32 v71, v63, 16, v62
    buffer_store_dwordx4 v[68:71], v2, s[12:15], s62 offen sc1
    s_nop 1
k1_kernel_noswz3s17:
    s_cmp_ge_u32 s2, 32
    s_cbranch_scc1 k1_kernel_nozero18
    s_cmp_lg_u32 s25, 0
    s_cbranch_scc1 k1_kernel_nozero18
    s_lshl_b32 s53, s2, 8
    s_add_u32 s53, s53, 0x1180000
    v_lshlrev_b32 v2, 2, v1
    v_mov_b32 v4, 0
    buffer_store_dword v4, v2, s[12:15], s53 offen sc0 sc1
k1_kernel_nozero18:
    s_setprio 1
    ds_read_b128 v[32:35], v3 offset:0
    ds_read_b128 v[36:39], v3 offset:1024
    ds_read_b128 v[40:43], v3 offset:2048
    ds_read_b128 v[44:47], v3 offset:3072
    ds_read_b128 v[48:51], v3 offset:4096
    ds_read_b128 v[52:55], v3 offset:5120
    ds_read_b128 v[56:59], v3 offset:6144
    ds_read_b128 v[60:63], v3 offset:7168
    v_lshlrev_b32 v5, 4, v8
    v_add_u32 v5, 147456, v5
    s_lshl_b32 s29, s27, 2
    s_mov_b32 s59, s42
    s_waitcnt lgkmcnt(0)
    s_branch k1_fepi
k1_end:
    s_endpgm
.text
.globl k2_kernel
.p2align 8
.type k2_kernel,@function
k2_kernel:
    s_cmp_ge_u32 s2, 256
    s_cbranch_scc1 k2_end
    s_load_dwordx2 s[20:21], s[0:1], 72
    v_lshrrev_b32 v2, 6, v0
    v_and_b32 v1, 63, v0
    v_readfirstlane_b32 s8, v2
    s_and_b32 s9, s2, 31
    s_lshr_b32 s10, s2, 5
    s_lshl_b32 s10, s10, 3
    v_lshlrev_b32 v4, 4, v1
    s_add_u32 s10, s10, s8
    s_lshl_b32 s12, s9, 16
    s_lshl_b32 s13, s10, 10
    s_add_u32 s25, s13, s12
    s_lshl_b32 s24, s8, 10
    s_add_u32 s12, s12, s24
    s_add_u32 s22, s12, 0x200000
    s_add_u32 s23, s12, 0x400000
    s_waitcnt lgkmcnt(0)
    s_mov_b32 s4, s20
    s_and_b32 s5, s21, 0xffff
    s_mov_b32 s6, 0x10000000
    s_mov_b32 s7, 0x20000
    buffer_load_dwordx4 v[8:11], v4, s[4:7], s25 offen
    s_add_u32 m0, s24, 0
    s_add_u32 s26, s22, 0
    buffer_load_dwordx4 v4, s[4:7], s26 offen lds
    s_add_u32 m0, s24, 65536
    s_add_u32 s26, s23, 0
    buffer_load_dwordx4 v4, s[4:7], s26 offen lds
    s_add_u32 m0, s24, 8192
    s_add_u32 s26, s22, 8192
    buffer_load_dwordx4 v4, s[4:7], s26 offen lds
    s_add_u32 m0, s24, 73728
    s_add_u32 s26, s23, 8192
    buffer_load_dwordx4 v4, s[4:7], s26 offen lds
    v_lshlrev_b32 v7, 4, v0
    v_add_u32 v7, 131072, v7
    v_mov_b32 v112, 0
    v_mov_b32 v113, 0
    v_mov_b32 v114, 0
    v_mov_b32 v115, 0
    v_and_b32 v12, 31, v0
    v_cmp_eq_u32 vcc, 0, v12
    v_mov_b32 v13, 0x3f803f80
    s_nop 0
    v_cndmask_b32 v112, v112, v13, vcc
    v_cndmask_b32 v113, v113, v13, vcc
    v_cndmask_b32 v114, v114, v13, vcc
    v_cndmask_b32 v115, v115, v13, vcc
    ds_write_b128 v7, v[112:115]
    v_mov_b32 v116, 0
    v_mov_b32 v117, 0
    v_mov_b32 v118, 0
    v_mov_b32 v119, 0
    v_mov_b32 v7, 139264
    v_lshl_add_u32 v7, v1, 2, v7
    ds_write_b32 v7, v116
    v_lshrrev_b32 v7, 5, v1
    v_lshlrev_b32 v7, 8, v7
    v_and_b32 v12, 15, v1
    v_lshl_add_u32 v7, v12, 4, v7
    v_add_u32 v6, 0x10000, v7
    v_mov_b32 v5, 8192
    v_and_b32 v12, 31, v1
    v_mov_b32 v13, 131088
    v_mov_b32 v14, 0
    v_cmp_lt_u32 vcc, 15, v12
    s_nop 1
    v_cndmask_b32 v6, v6, v13, vcc
    v_cndmask_b32 v5, v5, v14, vcc
    v_mov_b32 v13, 131072
    v_cmp_eq_u32 vcc, 16, v12
    s_nop 1
    v_cndmask_b32 v6, v6, v13, vcc
    v_subrev_u32 v14, 20, v12
    v_mov_b32 v13, 131136
    v_cmp_gt_u32 vcc, 8, v14
    s_nop 1
    v_cndmask_b32 v6, v6, v13, vcc
    s_mov_b32 s14, 0
    s_and_b32 s34, s2, 7
    s_lshr_b32 s12, s2, 3
    s_and_b32 s12, s12, 3
    s_lshl_b32 s12, s12, 3
    s_add_u32 s34, s34, s12
    s_lshr_b32 s35, s2, 5
    s_lshr_b32 s12, s8, 2
    s_mul_i32 s12, s12, 56
    s_add_u32 s12, s12, 32
    s_lshl_b32 s36, s34, 1
    s_bfe_u32 s13, s8, 0x10001
    s_add_u32 s36, s36, s13
    s_mul_i32 s36, s36, 144
    s_add_u32 s36, s36, s12
    s_lshl_b32 s36, s36, 10
    s_add_u32 s36, s36, 0x600000
    s_lshl_b32 s38, s12, 4
    s_lshl_b32 s13, s35, 1
    s_add_u32 s38, s38, s13
    s_and_b32 s13, s8, 1
    s_add_u32 s38, s38, s13
    s_lshl_b32 s38, s38, 10
    s_add_u32 s38, s38, 0xf00000
    s_lshr_b32 s58, s8, 2
    s_lshl_b32 s58, s58, 8
    s_lshl_b32 s13, s35, 1
    s_add_u32 s58, s58, s13
    s_and_b32 s13, s8, 1
    s_add_u32 s58, s58, s13
    s_lshl_b32 s58, s58, 10
    s_add_u32 s58, s58, 0xf00000
    s_waitcnt vmcnt(2) lgkmcnt(0)
    s_barrier
    ds_read_b128 v[88:91], v4
    s_waitcnt lgkmcnt(0)
    v_mfma_f32_32x32x16_bf16 v[48:63], v[88:91], v[8:11], 0
    s_nop 15
    v_max3_f32 v112, v48, v49, v50
    v_max3_f32 v112, v112, v51, v52
    v_max3_f32 v112, v112, v53, v54
    v_max3_f32 v112, v112, v55, v56
    v_max3_f32 v112, v112, v57, v58
    v_max3_f32 v112, v112, v59, v60
    v_max3_f32 v112, v112, v61, v62
    v_max_f32 v112, v112, v63
k2_kernel_restart1:
    v_mov_b32 v113, v112
    v_mov_b32 v2, v4
    v_mov_b32 v3, v6
    v_permlane32_swap_b32 v112, v113
    ds_read_b128 v[88:91], v2
    ds_read_b128 v[96:99], v3
    ds_read_b128 v[100:103], v3 offset:512
    ds_read_b128 v[92:95], v2 offset:1024
    v_max_f32 v112, v112, v113
    v_sub_f32 v16, 0, v112
    v_sub_f32 v17, 0, v112
    v_sub_f32 v18, 0, v112
    v_sub_f32 v19, 0, v112
    v_sub_f32 v20, 0, v112
    v_sub_f32 v21, 0, v112
    v_sub_f32 v22, 0, v112
    v_sub_f32 v23, 0, v112
    v_sub_f32 v24, 0, v112
    v_sub_f32 v25, 0, v112
    v_sub_f32 v26, 0, v112
    v_sub_f32 v27, 0, v112
    v_sub_f32 v28, 0, v112
    v_sub_f32 v29, 0, v112
    v_sub_f32 v30, 0, v112
    v_sub_f32 v31, 0, v112
    v_mov_b32 v32, 0
    v_mov_b32 v33, 0
    v_mov_b32 v34, 0
    v_mov_b32 v35, 0
    v_mov_b32 v36, 0
    v_mov_b32 v37, 0
    v_mov_b32 v38, 0
    v_mov_b32 v39, 0
    v_mov_b32 v40, 0
    v_mov_b32 v41, 0
    v_mov_b32 v42, 0
    v_mov_b32 v43, 0
    v_mov_b32 v44, 0
    v_mov_b32 v45, 0
    v_mov_b32 v46, 0
    v_mov_b32 v47, 0
    v_mov_b32 v104, 0
    v_mov_b32 v105, 0
    v_mov_b32 v106, 0
    v_mov_b32 v107, 0
    v_mov_b32 v108, 0
    v_mov_b32 v109, 0
    v_mov_b32 v110, 0
    v_mov_b32 v111, 0
    v_mov_b32 v80, 0
    v_mov_b32 v81, 0
    v_mov_b32 v82, 0
    v_mov_b32 v83, 0
    v_mov_b32 v84, 0
    v_mov_b32 v85, 0
    v_mov_b32 v86, 0
    v_mov_b32 v87, 0
    v_mov_b32 v76, 0
    v_mov_b32 v77, 0
    v_mov_b32 v78, 0
    v_mov_b32 v79, 0
    v_mov_b32 v128, 0
    v_mov_b32 v129, 0
    v_mov_b32 v130, 0
    v_mov_b32 v131, 0
    v_mov_b32 v132, 0
    v_mov_b32 v133, 0
    v_mov_b32 v134, 0
    v_mov_b32 v135, 0
    v_mov_b32 v136, 0
    v_mov_b32 v137, 0
    v_mov_b32 v138, 0
    v_mov_b32 v139, 0
    v_mov_b32 v140, 0
    v_mov_b32 v141, 0
    v_mov_b32 v142, 0
    v_mov_b32 v143, 0
    s_mov_b32 s28, s36
    s_mov_b32 s29, 1024
    s_mov_b32 s39, 16384
    s_mul_i32 s30, s14, 16384
    s_sub_u32 s30, s38, s30
    s_waitcnt lgkmcnt(0)
    v_mfma_f32_32x32x16_bf16 v[48:63], v[88:91], v[8:11], v[16:31]
    s_nop 15
    s_mov_b32 s11, 0
    s_cmp_eq_u32 s14, 1
    s_cbranch_scc1 k2_kernel_loop3
    s_cmp_ge_u32 s8, 4
    s_cbranch_scc1 k2_kernel_r26
    v_exp_f32 v48, v48
    v_cvt_pk_bf16_f32 v86, v76, v77
    v_exp_f32 v49, v49
    v_exp_f32 v50, v50
    v_cvt_pk_bf16_f32 v87, v78, v79
    v_exp_f32 v51, v51
    v_exp_f32 v52, v52
    v_mfma_f32_32x32x16_bf16 v[32:47], v[108:111], v[84:87], v[32:47]
    ds_read_b128 v[104:107], v3 offset:1024
    v_cvt_pk_bf16_f32 v80, v48, v49
    v_exp_f32 v53, v53
    v_exp_f32 v54, v54
    v_cvt_pk_bf16_f32 v81, v50, v51
    s_waitcnt lgkmcnt(1)
    v_exp_f32 v55, v55
    v_mfma_f32_32x32x16_bf16 v[64:79], v[92:95], v[8:11], v[16:31]
    ds_read_b128 v[108:111], v3 offset:1536
    v_exp_f32 v56, v56
    v_cvt_pk_bf16_f32 v82, v52, v53
    v_exp_f32 v57, v57
    v_exp_f32 v58, v58
    v_cvt_pk_bf16_f32 v83, v54, v55
    v_exp_f32 v59, v59
    s_add_u32 m0, s24, 16384
    s_add_u32 s26, s22, 16384
    buffer_load_dwordx4 v4, s[4:7], s26 offen lds
    s_add_u32 m0, s24, 81920
    s_add_u32 s26, s23, 16384
    buffer_load_dwordx4 v4, s[4:7], s26 offen lds
    v_exp_f32 v60, v60
    v_mfma_f32_32x32x16_bf16 v[32:47], v[96:99], v[80:83], v[32:47]
    ds_read_b128 v[88:91], v2 offset:2048
    v_cvt_pk_bf16_f32 v84, v56, v57
    v_exp_f32 v61, v61
    v_exp_f32 v62, v62
    v_cvt_pk_bf16_f32 v85, v58, v59
    buffer_load_dwordx4 v[144:147], v4, s[4:7], s28 offen
    s_add_u32 s28, s28, s29
    v_exp_f32 v63, v63
    v_exp_f32 v64, v64
    v_cvt_pk_bf16_f32 v86, v60, v61
    v_exp_f32 v65, v65
    v_exp_f32 v66, v66
    v_cvt_pk_bf16_f32 v87, v62, v63
    v_exp_f32 v67, v67
    v_exp_f32 v68, v68
    v_mfma_f32_32x32x16_bf16 v[32:47], v[100:103], v[84:87], v[32:47]
    ds_read_b128 v[96:99], v3 offset:2048
    buffer_load_dwordx4 v[148:151], v4, s[4:7], s30 offen
    s_add_u32 s30, s30, s39
    v_cvt_pk_bf16_f32 v80, v64, v65
    v_exp_f32 v69, v69
    v_exp_f32 v70, v70
    v_cvt_pk_bf16_f32 v81, v66, v67
    s_waitcnt lgkmcnt(1)
    v_exp_f32 v71, v71
    v_mfma_f32_32x32x16_bf16 v[48:63], v[88:91], v[8:11], v[16:31]
    ds_read_b128 v[100:103], v3 offset:2560
    v_exp_f32 v72, v72
    v_cvt_pk_bf16_f32 v82, v68, v69
    v_exp_f32 v73, v73
    v_exp_f32 v74, v74
    v_cvt_pk_bf16_f32 v83, v70, v71
    v_exp_f32 v75, v75
    s_add_u32 m0, s24, 24576
    s_add_u32 s26, s22, 24576
    buffer_load_dwordx4 v4, s[4:7], s26 offen lds
    s_add_u32 m0, s24, 90112
    s_add_u32 s26, s23, 24576
    buffer_load_dwordx4 v4, s[4:7], s26 offen lds
    v_exp_f32 v76, v76
    v_mfma_f32_32x32x16_bf16 v[32:47], v[104:107], v[80:83], v[32:47]
    ds_read_b128 v[92:95], v2 offset:3072
    v_cvt_pk_bf16_f32 v84, v72, v73
    v_exp_f32 v77, v77
    v_exp_f32 v78, v78
    v_cvt_pk_bf16_f32 v85, v74, v75
    buffer_load_dwordx4 v[152:155], v4, s[4:7], s28 offen
    s_add_u32 s28, s28, s29
    v_exp_f32 v79, v79
    v_exp_f32 v48, v48
    v_cvt_pk_bf16_f32 v86, v76, v77
    v_exp_f32 v49, v49
    v_exp_f32 v50, v50
    v_cvt_pk_bf16_f32 v87, v78, v79
    v_exp_f32 v51, v51
    v_exp_f32 v52, v52
    v_mfma_f32_32x32x16_bf16 v[32:47], v[108:111], v[84:87], v[32:47]
    ds_read_b128 v[104:107], v3 offset:3072
    buffer_load_dwordx4 v[156:159], v4, s[4:7], s30 offen
    s_add_u32 s30, s30, s39
    v_cvt_pk_bf16_f32 v80, v48, v49
    v_exp_f32 v53, v53
    v_exp_f32 v54, v54
    v_cvt_pk_bf16_f32 v81, v50, v51
    s_waitcnt lgkmcnt(1)
    v_exp_f32 v55, v55
    v_mfma_f32_32x32x16_bf16 v[64:79], v[92:95], v[8:11], v[16:31]
    ds_read_b128 v[108:111], v3 offset:3584
    v_exp_f32 v56, v56
    v_cvt_pk_bf16_f32 v82, v52, v53
    v_exp_f32 v57, v57
    v_exp_f32 v58, v58
    v_cvt_pk_bf16_f32 v83, v54, v55
    v_exp_f32 v59, v59
    s_add_u32 m0, s24, 32768
    s_add_u32 s26, s22, 32768
    buffer_load_dwordx4 v4, s[4:7], s26 offen lds
    s_add_u32 m0, s24, 98304
    s_add_u32 s26, s23, 32768
    buffer_load_dwordx4 v4, s[4:7], s26 offen lds
    v_exp_f32 v60, v60
    v_mfma_f32_32x32x16_bf16 v[32:47], v[96:99], v[80:83], v[32:47]
    ds_read_b128 v[88:91], v2 offset:4096
    v_cvt_pk_bf16_f32 v84, v56, v57
    v_exp_f32 v61, v61
    v_exp_f32 v62, v62
    v_cvt_pk_bf16_f32 v85, v58, v59
    buffer_load_dwordx4 v[160:163], v4, s[4:7], s28 offen
    s_add_u32 s28, s28, s29
    v_exp_f32 v63, v63
    v_exp_f32 v64, v64
    v_cvt_pk_bf16_f32 v86, v60, v61
    v_exp_f32 v65, v65
    v_exp_f32 v66, v66
    v_cvt_pk_bf16_f32 v87, v62, v63
    v_exp_f32 v67, v67
    v_exp_f32 v68, v68
    v_mfma_f32_32x32x16_bf16 v[32:47], v[100:103], v[84:87], v[32:47]
    ds_read_b128 v[96:99], v3 offset:4096
    buffer_load_dwordx4 v[164:167], v4, s[4:7], s30 offen
    s_add_u32 s30, s30, s39
    v_cvt_pk_bf16_f32 v80, v64, v65
    v_exp_f32 v69, v69
    v_exp_f32 v70, v70
    v_cvt_pk_bf16_f32 v81, v66, v67
    s_waitcnt lgkmcnt(1)
    v_exp_f32 v71, v71
    v_mfma_f32_32x32x16_bf16 v[48:63], v[88:91], v[8:11], v[16:31]
    ds_read_b128 v[100:103], v3 offset:4608
    v_exp_f32 v72, v72
    v_cvt_pk_bf16_f32 v82, v68, v69
    v_exp_f32 v73, v73
    v_exp_f32 v74, v74
    v_cvt_pk_bf16_f32 v83, v70, v71
    v_exp_f32 v75, v75
    s_add_u32 m0, s24, 40960
    s_add_u32 s26, s22, 40960
    buffer_load_dwordx4 v4, s[4:7], s26 offen lds
    s_add_u32 m0, s24, 106496
    s_add_u32 s26, s23, 40960
    buffer_load_dwordx4 v4, s[4:7], s26 offen lds
    v_exp_f32 v76, v76
    v_mfma_f32_32x32x16_bf16 v[32:47], v[104:107], v[80:83], v[32:47]
    ds_read_b128 v[92:95], v2 offset:5120
    v_cvt_pk_bf16_f32 v84, v72, v73
    v_exp_f32 v77, v77
    v_exp_f32 v78, v78
    v_cvt_pk_bf16_f32 v85, v74, v75
    buffer_load_dwordx4 v[168:171], v4, s[4:7], s28 offen
    s_add_u32 s28, s28, s29
    v_exp_f32 v79, v79
    v_exp_f32 v48, v48
    v_cvt_pk_bf16_f32 v86, v76, v77
    v_exp_f32 v49, v49
    v_exp_f32 v50, v50
    v_cvt_pk_bf16_f32 v87, v78, v79
    v_exp_f32 v51, v51
    v_exp_f32 v52, v52
    v_mfma_f32_32x32x16_bf16 v[32:47], v[108:111], v[84:87], v[32:47]
    ds_read_b128 v[104:107], v3 offset:5120
    buffer_load_dwordx4 v[172:175], v4, s[4:7], s30 offen
    s_add_u32 s30, s30, s39
    v_cvt_pk_bf16_f32 v80, v48, v49
    v_exp_f32 v53, v53
    v_exp_f32 v54, v54
    v_cvt_pk_bf16_f32 v81, v50, v51
    s_waitcnt lgkmcnt(1)
    v_exp_f32 v55, v55
    v_mfma_f32_32x32x16_bf16 v[64:79], v[92:95], v[8:11], v[16:31]
    ds_read_b128 v[108:111], v3 offset:5632
    v_exp_f32 v56, v56
    v_cvt_pk_bf16_f32 v82, v52, v53
    v_exp_f32 v57, v57
    v_exp_f32 v58, v58
    v_cvt_pk_bf16_f32 v83, v54, v55
    v_exp_f32 v59, v59
    s_add_u32 m0, s24, 49152
    s_add_u32 s26, s22, 49152
    buffer_load_dwordx4 v4, s[4:7], s26 offen lds
    s_add_u32 m0, s24, 114688
    s_add_u32 s26, s23, 49152
    buffer_load_dwordx4 v4, s[4:7], s26 offen lds
    v_exp_f32 v60, v60
    v_mfma_f32_32x32x16_bf16 v[32:47], v[96:99], v[80:83], v[32:47]
    ds_read_b128 v[88:91], v2 offset:6144
    v_cvt_pk_bf16_f32 v84, v56, v57
    v_exp_f32 v61, v61
    v_exp_f32 v62, v62
    v_cvt_pk_bf16_f32 v85, v58, v59
    buffer_load_dwordx4 v[176:179], v4, s[4:7], s28 offen
    s_add_u32 s28, s28, s29
    v_exp_f32 v63, v63
    s_waitcnt vmcnt(19)
    s_barrier
    v_exp_f32 v64, v64
    v_cvt_pk_bf16_f32 v86, v60, v61
    v_exp_f32 v65, v65
    v_exp_f32 v66, v66
    v_cvt_pk_bf16_f32 v87, v62, v63
    v_exp_f32 v67, v67
    v_exp_f32 v68, v68
    v_mfma_f32_32x32x16_bf16 v[32:47], v[100:103], v[84:87], v[32:47]
    ds_read_b128 v[96:99], v3 offset:6144
    buffer_load_dwordx4 v[180:183], v4, s[4:7], s30 offen
    s_add_u32 s30, s30, s39
    v_cvt_pk_bf16_f32 v80, v64, v65
    v_exp_f32 v69, v69
    v_exp_f32 v70, v70
    v_cvt_pk_bf16_f32 v81, v66, v67
    s_waitcnt lgkmcnt(1)
    v_exp_f32 v71, v71
    v_mfma_f32_32x32x16_bf16 v[48:63], v[88:91], v[8:11], v[16:31]
    ds_read_b128 v[100:103], v3 offset:6656
    v_exp_f32 v72, v72
    v_cvt_pk_bf16_f32 v82, v68, v69
    v_exp_f32 v73, v73
    v_exp_f32 v74, v74
    v_cvt_pk_bf16_f32 v83, v70, v71
    v_exp_f32 v75, v75
    s_add_u32 m0, s24, 57344
    s_add_u32 s26, s22, 57344
    buffer_load_dwordx4 v4, s[4:7], s26 offen lds
    s_add_u32 m0, s24, 122880
    s_add_u32 s26, s23, 57344
    buffer_load_dwordx4 v4, s[4:7], s26 offen lds
    v_exp_f32 v76, v76
    v_mfma_f32_32x32x16_bf16 v[32:47], v[104:107], v[80:83], v[32:47]
    ds_read_b128 v[92:95], v2 offset:7168
    v_cvt_pk_bf16_f32 v84, v72, v73
    v_exp_f32 v77, v77
    v_exp_f32 v78, v78
    v_cvt_pk_bf16_f32 v85, v74, v75
    buffer_load_dwordx4 v[184:187], v4, s[4:7], s28 offen
    s_add_u32 s28, s28, s29
    v_exp_f32 v79, v79
    v_exp_f32 v48, v48
    v_cvt_pk_bf16_f32 v86, v76, v77
    v_exp_f32 v49, v49
    v_exp_f32 v50, v50
    v_cvt_pk_bf16_f32 v87, v78, v79
    v_exp_f32 v51, v51
    v_exp_f32 v52, v52
    v_mfma_f32_32x32x16_bf16 v[32:47], v[108:111], v[84:87], v[32:47]
    ds_read_b128 v[104:107], v3 offset:7168
    buffer_load_dwordx4 v[188:191], v4, s[4:7], s30 offen
    s_add_u32 s30, s30, s39
    v_cvt_pk_bf16_f32 v80, v48, v49
    v_exp_f32 v53, v53
    v_exp_f32 v54, v54
    v_cvt_pk_bf16_f32 v81, v50, v51
    s_waitcnt lgkmcnt(1)
    v_exp_f32 v55, v55
    v_mfma_f32_32x32x16_bf16 v[64:79], v[92:95], v[8:11], v[16:31]
    ds_read_b128 v[108:111], v3 offset:7680
    v_exp_f32 v56, v56
    v_cvt_pk_bf16_f32 v82, v52, v53
    v_exp_f32 v57, v57
    v_exp_f32 v58, v58
    v_cvt_pk_bf16_f32 v83, v54, v55
    v_exp_f32 v59, v59
    v_exp_f32 v60, v60
    v_mfma_f32_32x32x16_bf16 v[32:47], v[96:99], v[80:83], v[32:47]
    ds_read_b128 v[88:91], v2 offset:8192
    v_cvt_pk_bf16_f32 v84, v56, v57
    v_exp_f32 v61, v61
    v_exp_f32 v62, v62
    v_cvt_pk_bf16_f32 v85, v58, v59
    buffer_load_dwordx4 v[192:195], v4, s[4:7], s28 offen
    s_add_u32 s28, s28, s29
    v_exp_f32 v63, v63
    v_exp_f32 v64, v64
    v_add_u32 v3, v5, v3
    v_cvt_pk_bf16_f32 v86, v60, v61
    v_exp_f32 v65, v65
    v_exp_f32 v66, v66
    v_cvt_pk_bf16_f32 v87, v62, v63
    v_exp_f32 v67, v67
    v_exp_f32 v68, v68
    v_mfma_f32_32x32x16_bf16 v[32:47], v[100:103], v[84:87], v[32:47]
    ds_read_b128 v[96:99], v3 offset:0
    buffer_load_dwordx4 v[196:199], v4, s[4:7], s30 offen
    s_add_u32 s30, s30, s39
    v_cvt_pk_bf16_f32 v80, v64, v65
    v_exp_f32 v69, v69
    v_exp_f32 v70, v70
    v_cvt_pk_bf16_f32 v81, v66, v67
    s_waitcnt lgkmcnt(1)
    v_exp_f32 v71, v71
    v_mfma_f32_32x32x16_bf16 v[48:63], v[88:91], v[8:11], v[16:31]
    ds_read_b128 v[100:103], v3 offset:512
    v_exp_f32 v72, v72
    v_cvt_pk_bf16_f32 v82, v68, v69
    v_exp_f32 v73, v73
    v_exp_f32 v74, v74
    v_cvt_pk_bf16_f32 v83, v70, v71
    v_exp_f32 v75, v75
    v_exp_f32 v76, v76
    v_mfma_f32_32x32x16_bf16 v[32:47], v[104:107], v[80:83], v[32:47]
    ds_read_b128 v[92:95], v2 offset:9216
    v_cvt_pk_bf16_f32 v84, v72, v73
    v_exp_f32 v77, v77
    v_add_u32 v2, 8192, v2
    v_exp_f32 v78, v78
    v_cvt_pk_bf16_f32 v85, v74, v75
    buffer_load_dwordx4 v[200:203], v4, s[4:7], s28 offen
    s_add_u32 s28, s28, s29
    s_add_u32 s11, s11, 1
    s_cmp_lt_u32 s11, 8
    v_exp_f32 v79, v79
    s_waitcnt vmcnt(0)
    s_barrier
k2_kernel_loop3:
    v_exp_f32 v48, v48
    v_cvt_pk_bf16_f32 v86, v76, v77
    v_exp_f32 v49, v49
    v_exp_f32 v50, v50
    v_cvt_pk_bf16_f32 v87, v78, v79
    v_exp_f32 v51, v51
    v_exp_f32 v52, v52
    v_mfma_f32_32x32x16_bf16 v[32:47], v[108:111], v[84:87], v[32:47]
    ds_read_b128 v[104:107], v3 offset:1024
    buffer_load_dwordx4 v[204:207], v4, s[4:7], s30 offen
    s_add_u32 s30, s30, s39
    s_add_u32 s31, s58, 16384
    s_cmp_lt_u32 s11, 7
    s_cselect_b32 s30, s30, s31
    s_cselect_b32 s28, s28, s58
    s_cselect_b32 s29, s29, 0x8000
    s_cselect_b32 s39, s39, 0x8000
    v_cvt_pk_bf16_f32 v80, v48, v49
    v_exp_f32 v53, v53
    v_exp_f32 v54, v54
    v_cvt_pk_bf16_f32 v81, v50, v51
    s_waitcnt lgkmcnt(1)
    v_exp_f32 v55, v55
    v_mfma_f32_32x32x16_bf16 v[64:79], v[92:95], v[8:11], v[16:31]
    ds_read_b128 v[108:111], v3 offset:1536
    v_exp_f32 v56, v56
    v_cvt_pk_bf16_f32 v82, v52, v53
    v_exp_f32 v57, v57
    v_exp_f32 v58, v58
    v_cvt_pk_bf16_f32 v83, v54, v55
    v_exp_f32 v59, v59
    v_exp_f32 v60, v60
    v_mfma_f32_32x32x16_bf16 v[32:47], v[96:99], v[80:83], v[32:47]
    ds_read_b128 v[88:91], v2 offset:2048
    v_cvt_pk_bf16_f32 v84, v56, v57
    v_exp_f32 v61, v61
    v_exp_f32 v62, v62
    v_cvt_pk_bf16_f32 v85, v58, v59
    s_waitcnt vmcnt(14)
    v_mfma_f32_32x32x16_bf16 v[128:143], v[148:151], v[144:147], v[128:143]
    buffer_load_dwordx4 v[144:147], v4, s[4:7], s28 offen
    s_add_u32 s28, s28, s29
    v_exp_f32 v63, v63
    v_exp_f32 v64, v64
    v_cvt_pk_bf16_f32 v86, v60, v61
    v_exp_f32 v65, v65
    v_exp_f32 v66, v66
    v_cvt_pk_bf16_f32 v87, v62, v63
    v_exp_f32 v67, v67
    v_exp_f32 v68, v68
    v_mfma_f32_32x32x16_bf16 v[32:47], v[100:103], v[84:87], v[32:47]
    ds_read_b128 v[96:99], v3 offset:2048
    buffer_load_dwordx4 v[148:151], v4, s[4:7], s30 offen
    s_add_u32 s30, s30, s39
    v_cvt_pk_bf16_f32 v80, v64, v65
    v_exp_f32 v69, v69
    v_exp_f32 v70, v70
    v_cvt_pk_bf16_f32 v81, v66, v67
    s_waitcnt lgkmcnt(1)
    v_exp_f32 v71, v71
    v_mfma_f32_32x32x16_bf16 v[48:63], v[88:91], v[8:11], v[16:31]
    ds_read_b128 v[100:103], v3 offset:2560
    v_exp_f32 v72, v72
    v_cvt_pk_bf16_f32 v82, v68, v69
    v_exp_f32 v73, v73
    v_exp_f32 v74, v74
    v_cvt_pk_bf16_f32 v83, v70, v71
    v_exp_f32 v75, v75
    v_exp_f32 v76, v76
    v_mfma_f32_32x32x16_bf16 v[32:47], v[104:107], v[80:83], v[32:47]
    ds_read_b128 v[92:95], v2 offset:3072
    v_cvt_pk_bf16_f32 v84, v72, v73
    v_exp_f32 v77, v77
    v_exp_f32 v78, v78
    v_cvt_pk_bf16_f32 v85, v74, v75
    s_waitcnt vmcnt(14)
    v_mfma_f32_32x32x16_bf16 v[128:143], v[156:159], v[152:155], v[128:143]
    buffer_load_dwordx4 v[152:155], v4, s[4:7], s28 offen
    s_add_u32 s28, s28, s29
    v_exp_f32 v79, v79
    v_exp_f32 v48, v48
    v_cvt_pk_bf16_f32 v86, v76, v77
    v_exp_f32 v49, v49
    v_exp_f32 v50, v50
    v_cvt_pk_bf16_f32 v87, v78, v79
    v_exp_f32 v51, v51
    v_exp_f32 v52, v52
    v_mfma_f32_32x32x16_bf16 v[32:47], v[108:111], v[84:87], v[32:47]
    ds_read_b128 v[104:107], v3 offset:3072
    buffer_load_dwordx4 v[156:159], v4, s[4:7], s30 offen
    s_add_u32 s30, s30, s39
    v_cvt_pk_bf16_f32 v80, v48, v49
    v_exp_f32 v53, v53
    v_exp_f32 v54, v54
    v_cvt_pk_bf16_f32 v81, v50, v51
    s_waitcnt lgkmcnt(1)
    v_exp_f32 v55, v55
    v_mfma_f32_32x32x16_bf16 v[64:79], v[92:95], v[8:11], v[16:31]
    ds_read_b128 v[108:111], v3 offset:3584
    v_exp_f32 v56, v56
    v_cvt_pk_bf16_f32 v82, v52, v53
    v_exp_f32 v57, v57
    v_exp_f32 v58, v58
    v_cvt_pk_bf16_f32 v83, v54, v55
    v_exp_f32 v59, v59
    v_exp_f32 v60, v60
    v_mfma_f32_32x32x16_bf16 v[32:47], v[96:99], v[80:83], v[32:47]
    ds_read_b128 v[88:91], v2 offset:4096
    v_cvt_pk_bf16_f32 v84, v56, v57
    v_exp_f32 v61, v61
    v_exp_f32 v62, v62
    v_cvt_pk_bf16_f32 v85, v58, v59
    s_waitcnt vmcnt(14)
    v_mfma_f32_32x32x16_bf16 v[128:143], v[164:167], v[160:163], v[128:143]
    buffer_load_dwordx4 v[160:163], v4, s[4:7], s28 offen
    s_add_u32 s28, s28, s29
    v_exp_f32 v63, v63
    v_exp_f32 v64, v64
    v_cvt_pk_bf16_f32 v86, v60, v61
    v_exp_f32 v65, v65
    v_exp_f32 v66, v66
    v_cvt_pk_bf16_f32 v87, v62, v63
    v_exp_f32 v67, v67
    v_exp_f32 v68, v68
    v_mfma_f32_32x32x16_bf16 v[32:47], v[100:103], v[84:87], v[32:47]
    ds_read_b128 v[96:99], v3 offset:4096
    buffer_load_dwordx4 v[164:167], v4, s[4:7], s30 offen
    s_add_u32 s30, s30, s39
    v_cvt_pk_bf16_f32 v80, v64, v65
    v_exp_f32 v69, v69
    v_exp_f32 v70, v70
    v_cvt_pk_bf16_f32 v81, v66, v67
    s_waitcnt lgkmcnt(1)
    v_exp_f32 v71, v71
    v_mfma_f32_32x32x16_bf16 v[48:63], v[88:91], v[8:11], v[16:31]
    ds_read_b128 v[100:103], v3 offset:4608
    v_exp_f32 v72, v72
    v_cvt_pk_bf16_f32 v82, v68, v69
    v_exp_f32 v73, v73
    v_exp_f32 v74, v74
    v_cvt_pk_bf16_f32 v83, v70, v71
    v_exp_f32 v75, v75
    v_exp_f32 v76, v76
    v_mfma_f32_32x32x16_bf16 v[32:47], v[104:107], v[80:83], v[32:47]
    ds_read_b128 v[92:95], v2 offset:5120
    v_cvt_pk_bf16_f32 v84, v72, v73
    v_exp_f32 v77, v77
    v_exp_f32 v78, v78
    v_cvt_pk_bf16_f32 v85, v74, v75
    s_waitcnt vmcnt(14)
    v_mfma_f32_32x32x16_bf16 v[128:143], v[172:175], v[168:171], v[128:143]
    buffer_load_dwordx4 v[168:171], v4, s[4:7], s28 offen
    s_add_u32 s28, s28, s29
    v_exp_f32 v79, v79
    v_exp_f32 v48, v48
    v_cvt_pk_bf16_f32 v86, v76, v77
    v_exp_f32 v49, v49
    v_exp_f32 v50, v50
    v_cvt_pk_bf16_f32 v87, v78, v79
    v_exp_f32 v51, v51
    v_exp_f32 v52, v52
    v_mfma_f32_32x32x16_bf16 v[32:47], v[108:111], v[84:87], v[32:47]
    ds_read_b128 v[104:107], v3 offset:5120
    buffer_load_dwordx4 v[172:175], v4, s[4:7], s30 offen
    s_add_u32 s30, s30, s39
    v_cvt_pk_bf16_f32 v80, v48, v49
    v_exp_f32 v53, v53
    v_exp_f32 v54, v54
    v_cvt_pk_bf16_f32 v81, v50, v51
    s_waitcnt lgkmcnt(1)
    v_exp_f32 v55, v55
    v_mfma_f32_32x32x16_bf16 v[64:79], v[92:95], v[8:11], v[16:31]
    ds_read_b128 v[108:111], v3 offset:5632
    v_exp_f32 v56, v56
    v_cvt_pk_bf16_f32 v82, v52, v53
    v_exp_f32 v57, v57
    v_exp_f32 v58, v58
    v_cvt_pk_bf16_f32 v83, v54, v55
    v_exp_f32 v59, v59
    v_exp_f32 v60, v60
    v_mfma_f32_32x32x16_bf16 v[32:47], v[96:99], v[80:83], v[32:47]
    ds_read_b128 v[88:91], v2 offset:6144
    v_cvt_pk_bf16_f32 v84, v56, v57
    v_exp_f32 v61, v61
    v_exp_f32 v62, v62
    v_cvt_pk_bf16_f32 v85, v58, v59
    s_waitcnt vmcnt(14)
    v_mfma_f32_32x32x16_bf16 v[128:143], v[180:183], v[176:179], v[128:143]
    buffer_load_dwordx4 v[176:179], v4, s[4:7], s28 offen
    s_add_u32 s28, s28, s29
    v_exp_f32 v63, v63
    v_exp_f32 v64, v64
    v_cvt_pk_bf16_f32 v86, v60, v61
    v_exp_f32 v65, v65
    v_exp_f32 v66, v66
    v_cvt_pk_bf16_f32 v87, v62, v63
    v_exp_f32 v67, v67
    v_exp_f32 v68, v68
    v_mfma_f32_32x32x16_bf16 v[32:47], v[100:103], v[84:87], v[32:47]
    ds_read_b128 v[96:99], v3 offset:6144
    buffer_load_dwordx4 v[180:183], v4, s[4:7], s30 offen
    s_add_u32 s30, s30, s39
    v_cvt_pk_bf16_f32 v80, v64, v65
    v_exp_f32 v69, v69
    v_exp_f32 v70, v70
    v_cvt_pk_bf16_f32 v81, v66, v67
    s_waitcnt lgkmcnt(1)
    v_exp_f32 v71, v71
    v_mfma_f32_32x32x16_bf16 v[48:63], v[88:91], v[8:11], v[16:31]
    ds_read_b128 v[100:103], v3 offset:6656
    v_exp_f32 v72, v72
    v_cvt_pk_bf16_f32 v82, v68, v69
    v_exp_f32 v73, v73
    v_exp_f32 v74, v74
    v_cvt_pk_bf16_f32 v83, v70, v71
    v_exp_f32 v75, v75
    v_exp_f32 v76, v76
    v_mfma_f32_32x32x16_bf16 v[32:47], v[104:107], v[80:83], v[32:47]
    ds_read_b128 v[92:95], v2 offset:7168
    v_cvt_pk_bf16_f32 v84, v72, v73
    v_exp_f32 v77, v77
    v_exp_f32 v78, v78
    v_cvt_pk_bf16_f32 v85, v74, v75
    s_waitcnt vmcnt(14)
    v_mfma_f32_32x32x16_bf16 v[128:143], v[188:191], v[184:187], v[128:143]
    buffer_load_dwordx4 v[184:187], v4, s[4:7], s28 offen
    s_add_u32 s28, s28, s29
    v_exp_f32 v79, v79
    v_exp_f32 v48, v48
    v_cvt_pk_bf16_f32 v86, v76, v77
    v_exp_f32 v49, v49
    v_exp_f32 v50, v50
    v_cvt_pk_bf16_f32 v87, v78, v79
    v_exp_f32 v51, v51
    v_exp_f32 v52, v52
    v_mfma_f32_32x32x16_bf16 v[32:47], v[108:111], v[84:87], v[32:47]
    ds_read_b128 v[104:107], v3 offset:7168
    buffer_load_dwordx4 v[188:191], v4, s[4:7], s30 offen
    s_add_u32 s30, s30, s39
    v_cvt_pk_bf16_f32 v80, v48, v49
    v_exp_f32 v53, v53
    v_exp_f32 v54, v54
    v_cvt_pk_bf16_f32 v81, v50, v51
    s_waitcnt lgkmcnt(1)
    v_exp_f32 v55, v55
    v_mfma_f32_32x32x16_bf16 v[64:79], v[92:95], v[8:11], v[16:31]
    ds_read_b128 v[108:111], v3 offset:7680
    v_exp_f32 v56, v56
    v_cvt_pk_bf16_f32 v82, v52, v53
    v_exp_f32 v57, v57
    v_exp_f32 v58, v58
    v_cvt_pk_bf16_f32 v83, v54, v55
    v_exp_f32 v59, v59
    v_exp_f32 v60, v60
    v_mfma_f32_32x32x16_bf16 v[32:47], v[96:99], v[80:83], v[32:47]
    ds_read_b128 v[88:91], v2 offset:8192
    v_cvt_pk_bf16_f32 v84, v56, v57
    v_exp_f32 v61, v61
    v_exp_f32 v62, v62
    v_cvt_pk_bf16_f32 v85, v58, v59
    s_waitcnt vmcnt(14)
    v_mfma_f32_32x32x16_bf16 v[128:143], v[196:199], v[192:195], v[128:143]
    buffer_load_dwordx4 v[192:195], v4, s[4:7], s28 offen
    s_add_u32 s28, s28, s29
    v_exp_f32 v63, v63
    v_exp_f32 v64, v64
    v_add_u32 v3, v5, v3
    v_cvt_pk_bf16_f32 v86, v60, v61
    v_exp_f32 v65, v65
    v_exp_f32 v66, v66
    v_cvt_pk_bf16_f32 v87, v62, v63
    v_exp_f32 v67, v67
    v_exp_f32 v68, v68
    v_mfma_f32_32x32x16_bf16 v[32:47], v[100:103], v[84:87], v[32:47]
    ds_read_b128 v[96:99], v3 offset:0
    buffer_load_dwordx4 v[196:199], v4, s[4:7], s30 offen
    s_add_u32 s30, s30, s39
    v_cvt_pk_bf16_f32 v80, v64, v65
    v_exp_f32 v69, v69
    v_exp_f32 v70, v70
    v_cvt_pk_bf16_f32 v81, v66, v67
    s_waitcnt lgkmcnt(1)
    v_exp_f32 v71, v71
    v_mfma_f32_32x32x16_bf16 v[48:63], v[88:91], v[8:11], v[16:31]
    ds_read_b128 v[100:103], v3 offset:512
    v_exp_f32 v72, v72
    v_cvt_pk_bf16_f32 v82, v68, v69
    v_exp_f32 v73, v73
    v_exp_f32 v74, v74
    v_cvt_pk_bf16_f32 v83, v70, v71
    v_exp_f32 v75, v75
    v_exp_f32 v76, v76
    v_mfma_f32_32x32x16_bf16 v[32:47], v[104:107], v[80:83], v[32:47]
    ds_read_b128 v[92:95], v2 offset:9216
    v_cvt_pk_bf16_f32 v84, v72, v73
    v_exp_f32 v77, v77
    v_add_u32 v2, 8192, v2
    v_exp_f32 v78, v78
    v_cvt_pk_bf16_f32 v85, v74, v75
    s_waitcnt vmcnt(14)
    v_mfma_f32_32x32x16_bf16 v[128:143], v[204:207], v[200:203], v[128:143]
    buffer_load_dwordx4 v[200:203], v4, s[4:7], s28 offen
    s_add_u32 s28, s28, s29
    s_add_u32 s11, s11, 1
    s_cmp_lt_u32 s11, 8
    v_exp_f32 v79, v79
    s_cbranch_scc1 k2_kernel_loop3
    s_branch k2_kernel_after5
k2_kernel_r26:
    v_exp_f32 v48, v48
    s_setprio 1
    v_cvt_pk_bf16_f32 v86, v76, v77
    v_exp_f32 v49, v49
    v_exp_f32 v50, v50
    v_cvt_pk_bf16_f32 v87, v78, v79
    v_exp_f32 v51, v51
    v_exp_f32 v52, v52
    v_mfma_f32_32x32x16_bf16 v[32:47], v[108:111], v[84:87], v[32:47]
    ds_read_b128 v[104:107], v3 offset:1024
    v_cvt_pk_bf16_f32 v80, v48, v49
    v_exp_f32 v53, v53
    v_exp_f32 v54, v54
    v_cvt_pk_bf16_f32 v81, v50, v51
    s_waitcnt lgkmcnt(1)
    v_exp_f32 v55, v55
    v_mfma_f32_32x32x16_bf16 v[64:79], v[92:95], v[8:11], v[16:31]
    ds_read_b128 v[108:111], v3 offset:1536
    v_exp_f32 v56, v56
    v_cvt_pk_bf16_f32 v82, v52, v53
    v_exp_f32 v57, v57
    v_exp_f32 v58, v58
    v_cvt_pk_bf16_f32 v83, v54, v55
    v_exp_f32 v59, v59
    s_add_u32 m0, s24, 16384
    s_add_u32 s26, s22, 16384
    buffer_load_dwordx4 v4, s[4:7], s26 offen lds
    s_add_u32 m0, s24, 81920
    s_add_u32 s26, s23, 16384
    buffer_load_dwordx4 v4, s[4:7], s26 offen lds
    v_exp_f32 v60, v60
    v_mfma_f32_32x32x16_bf16 v[32:47], v[96:99], v[80:83], v[32:47]
    ds_read_b128 v[88:91], v2 offset:2048
    v_cvt_pk_bf16_f32 v84, v56, v57
    v_exp_f32 v61, v61
    v_exp_f32 v62, v62
    v_cvt_pk_bf16_f32 v85, v58, v59
    buffer_load_dwordx4 v[144:147], v4, s[4:7], s28 offen
    s_add_u32 s28, s28, s29
    v_exp_f32 v63, v63
    v_exp_f32 v64, v64
    v_cvt_pk_bf16_f32 v86, v60, v61
    v_exp_f32 v65, v65
    v_exp_f32 v66, v66
    v_cvt_pk_bf16_f32 v87, v62, v63
    v_exp_f32 v67, v67
    v_exp_f32 v68, v68
    v_mfma_f32_32x32x16_bf16 v[32:47], v[100:103], v[84:87], v[32:47]
    ds_read_b128 v[96:99], v3 offset:2048
    buffer_load_dwordx4 v[148:151], v4, s[4:7], s30 offen
    s_add_u32 s30, s30, s39
    v_cvt_pk_bf16_f32 v80, v64, v65
    v_exp_f32 v69, v69
    v_exp_f32 v70, v70
    v_cvt_pk_bf16_f32 v81, v66, v67
    s_waitcnt lgkmcnt(1)
    v_exp_f32 v71, v71
    v_mfma_f32_32x32x16_bf16 v[48:63], v[88:91], v[8:11], v[16:31]
    ds_read_b128 v[100:103], v3 offset:2560
    v_exp_f32 v72, v72
    v_cvt_pk_bf16_f32 v82, v68, v69
    v_exp_f32 v73, v73
    v_exp_f32 v74, v74
    v_cvt_pk_bf16_f32 v83, v70, v71
    v_exp_f32 v75, v75
    s_add_u32 m0, s24, 24576
    s_add_u32 s26, s22, 24576
    buffer_load_dwordx4 v4, s[4:7], s26 offen lds
    s_add_u32 m0, s24, 90112
    s_add_u32 s26, s23, 24576
    buffer_load_dwordx4 v4, s[4:7], s26 offen lds
    v_exp_f32 v76, v76
    v_mfma_f32_32x32x16_bf16 v[32:47], v[104:107], v[80:83], v[32:47]
    ds_read_b128 v[92:95], v2 offset:3072
    v_cvt_pk_bf16_f32 v84, v72, v73
    v_exp_f32 v77, v77
    v_exp_f32 v78, v78
    v_cvt_pk_bf16_f32 v85, v74, v75
    buffer_load_dwordx4 v[152:155], v4, s[4:7], s28 offen
    s_add_u32 s28, s28, s29
    v_exp_f32 v79, v79
    v_exp_f32 v48, v48
    v_cvt_pk_bf16_f32 v86, v76, v77
    v_exp_f32 v49, v49
    v_exp_f32 v50, v50
    v_cvt_pk_bf16_f32 v87, v78, v79
    v_exp_f32 v51, v51
    v_exp_f32 v52, v52
    v_mfma_f32_32x32x16_bf16 v[32:47], v[108:111], v[84:87], v[32:47]
    ds_read_b128 v[104:107], v3 offset:3072
    buffer_load_dwordx4 v[156:159], v4, s[4:7], s30 offen
    s_add_u32 s30, s30, s39
    v_cvt_pk_bf16_f32 v80, v48, v49
    v_exp_f32 v53, v53
    v_exp_f32 v54, v54
    v_cvt_pk_bf16_f32 v81, v50, v51
    s_waitcnt lgkmcnt(1)
    v_exp_f32 v55, v55
    v_mfma_f32_32x32x16_bf16 v[64:79], v[92:95], v[8:11], v[16:31]
    ds_read_b128 v[108:111], v3 offset:3584
    v_exp_f32 v56, v56
    v_cvt_pk_bf16_f32 v82, v52, v53
    v_exp_f32 v57, v57
    v_exp_f32 v58, v58
    v_cvt_pk_bf16_f32 v83, v54, v55
    v_exp_f32 v59, v59
    s_add_u32 m0, s24, 32768
    s_add_u32 s26, s22, 32768
    buffer_load_dwordx4 v4, s[4:7], s26 offen lds
    s_add_u32 m0, s24, 98304
    s_add_u32 s26, s23, 32768
    buffer_load_dwordx4 v4, s[4:7], s26 offen lds
    v_exp_f32 v60, v60
    v_mfma_f32_32x32x16_bf16 v[32:47], v[96:99], v[80:83], v[32:47]
    ds_read_b128 v[88:91], v2 offset:4096
    v_cvt_pk_bf16_f32 v84, v56, v57
    v_exp_f32 v61, v61
    v_exp_f32 v62, v62
    v_cvt_pk_bf16_f32 v85, v58, v59
    buffer_load_dwordx4 v[160:163], v4, s[4:7], s28 offen
    s_add_u32 s28, s28, s29
    v_exp_f32 v63, v63
    v_exp_f32 v64, v64
    v_cvt_pk_bf16_f32 v86, v60, v61
    v_exp_f32 v65, v65
    v_exp_f32 v66, v66
    v_cvt_pk_bf16_f32 v87, v62, v63
    v_exp_f32 v67, v67
    v_exp_f32 v68, v68
    v_mfma_f32_32x32x16_bf16 v[32:47], v[100:103], v[84:87], v[32:47]
    ds_read_b128 v[96:99], v3 offset:4096
    buffer_load_dwordx4 v[164:167], v4, s[4:7], s30 offen
    s_add_u32 s30, s30, s39
    v_cvt_pk_bf16_f32 v80, v64, v65
    v_exp_f32 v69, v69
    v_exp_f32 v70, v70
    v_cvt_pk_bf16_f32 v81, v66, v67
    s_waitcnt lgkmcnt(1)
    v_exp_f32 v71, v71
    v_mfma_f32_32x32x16_bf16 v[48:63], v[88:91], v[8:11], v[16:31]
    ds_read_b128 v[100:103], v3 offset:4608
    v_exp_f32 v72, v72
    v_cvt_pk_bf16_f32 v82, v68, v69
    v_exp_f32 v73, v73
    v_exp_f32 v74, v74
    v_cvt_pk_bf16_f32 v83, v70, v71
    v_exp_f32 v75, v75
    s_add_u32 m0, s24, 40960
    s_add_u32 s26, s22, 40960
    buffer_load_dwordx4 v4, s[4:7], s26 offen lds
    s_add_u32 m0, s24, 106496
    s_add_u32 s26, s23, 40960
    buffer_load_dwordx4 v4, s[4:7], s26 offen lds
    v_exp_f32 v76, v76
    v_mfma_f32_32x32x16_bf16 v[32:47], v[104:107], v[80:83], v[32:47]
    ds_read_b128 v[92:95], v2 offset:5120
    v_cvt_pk_bf16_f32 v84, v72, v73
    v_exp_f32 v77, v77
    v_exp_f32 v78, v78
    v_cvt_pk_bf16_f32 v85, v74, v75
    buffer_load_dwordx4 v[168:171], v4, s[4:7], s28 offen
    s_add_u32 s28, s28, s29
    v_exp_f32 v79, v79
    v_exp_f32 v48, v48
    v_cvt_pk_bf16_f32 v86, v76, v77
    v_exp_f32 v49, v49
    v_exp_f32 v50, v50
    v_cvt_pk_bf16_f32 v87, v78, v79
    v_exp_f32 v51, v51
    v_exp_f32 v52, v52
    v_mfma_f32_32x32x16_bf16 v[32:47], v[108:111], v[84:87], v[32:47]
    ds_read_b128 v[104:107], v3 offset:5120
    buffer_load_dwordx4 v[172:175], v4, s[4:7], s30 offen
    s_add_u32 s30, s30, s39
    v_cvt_pk_bf16_f32 v80, v48, v49
    v_exp_f32 v53, v53
    v_exp_f32 v54, v54
    v_cvt_pk_bf16_f32 v81, v50, v51
    s_waitcnt lgkmcnt(1)
    v_exp_f32 v55, v55
    v_mfma_f32_32x32x16_bf16 v[64:79], v[92:95], v[8:11], v[16:31]
    ds_read_b128 v[108:111], v3 offset:5632
    v_exp_f32 v56, v56
    v_cvt_pk_bf16_f32 v82, v52, v53
    v_exp_f32 v57, v57
    v_exp_f32 v58, v58
    v_cvt_pk_bf16_f32 v83, v54, v55
    v_exp_f32 v59, v59
    s_add_u32 m0, s24, 49152
    s_add_u32 s26, s22, 49152
    buffer_load_dwordx4 v4, s[4:7], s26 offen lds
    s_add_u32 m0, s24, 114688
    s_add_u32 s26, s23, 49152
    buffer_load_dwordx4 v4, s[4:7], s26 offen lds
    v_exp_f32 v60, v60
    v_mfma_f32_32x32x16_bf16 v[32:47], v[96:99], v[80:83], v[32:47]
    ds_read_b128 v[88:91], v2 offset:6144
    v_cvt_pk_bf16_f32 v84, v56, v57
    v_exp_f32 v61, v61
    v_exp_f32 v62, v62
    v_cvt_pk_bf16_f32 v85, v58, v59
    buffer_load_dwordx4 v[176:179], v4, s[4:7], s28 offen
    s_add_u32 s28, s28, s29
    v_exp_f32 v63, v63
    s_waitcnt vmcnt(19)
    s_barrier
    v_exp_f32 v64, v64
    v_cvt_pk_bf16_f32 v86, v60, v61
    v_exp_f32 v65, v65
    v_exp_f32 v66, v66
    v_cvt_pk_bf16_f32 v87, v62, v63
    v_exp_f32 v67, v67
    v_exp_f32 v68, v68
    v_mfma_f32_32x32x16_bf16 v[32:47], v[100:103], v[84:87], v[32:47]
    ds_read_b128 v[96:99], v3 offset:6144
    buffer_load_dwordx4 v[180:183], v4, s[4:7], s30 offen
    s_add_u32 s30, s30, s39
    v_cvt_pk_bf16_f32 v80, v64, v65
    v_exp_f32 v69, v69
    v_exp_f32 v70, v70
    v_cvt_pk_bf16_f32 v81, v66, v67
    s_waitcnt lgkmcnt(1)
    v_exp_f32 v71, v71
    v_mfma_f32_32x32x16_bf16 v[48:63], v[88:91], v[8:11], v[16:31]
    ds_read_b128 v[100:103], v3 offset:6656
    v_exp_f32 v72, v72
    v_cvt_pk_bf16_f32 v82, v68, v69
    v_exp_f32 v73, v73
    v_exp_f32 v74, v74
    v_cvt_pk_bf16_f32 v83, v70, v71
    v_exp_f32 v75, v75
    s_add_u32 m0, s24, 57344
    s_add_u32 s26, s22, 57344
    buffer_load_dwordx4 v4, s[4:7], s26 offen lds
    s_add_u32 m0, s24, 122880
    s_add_u32 s26, s23, 57344
    buffer_load_dwordx4 v4, s[4:7], s26 offen lds
    v_exp_f32 v76, v76
    v_mfma_f32_32x32x16_bf16 v[32:47], v[104:107], v[80:83], v[32:47]
    ds_read_b128 v[92:95], v2 offset:7168
    v_cvt_pk_bf16_f32 v84, v72, v73
    v_exp_f32 v77, v77
    v_exp_f32 v78, v78
    v_cvt_pk_bf16_f32 v85, v74, v75
    buffer_load_dwordx4 v[184:187], v4, s[4:7], s28 offen
    s_add_u32 s28, s28, s29
    v_exp_f32 v79, v79
    v_exp_f32 v48, v48
    s_setprio 0
    v_cvt_pk_bf16_f32 v86, v76, v77
    v_exp_f32 v49, v49
    v_exp_f32 v50, v50
    v_cvt_pk_bf16_f32 v87, v78, v79
    v_exp_f32 v51, v51
    v_exp_f32 v52, v52
    v_mfma_f32_32x32x16_bf16 v[32:47], v[108:111], v[84:87], v[32:47]
    ds_read_b128 v[104:107], v3 offset:7168
    buffer_load_dwordx4 v[188:191], v4, s[4:7], s30 offen
    s_add_u32 s30, s30, s39
    v_cvt_pk_bf16_f32 v80, v48, v49
    v_exp_f32 v53, v53
    v_exp_f32 v54, v54
    v_cvt_pk_bf16_f32 v81, v50, v51
    s_waitcnt lgkmcnt(1)
    v_exp_f32 v55, v55
    v_mfma_f32_32x32x16_bf16 v[64:79], v[92:95], v[8:11], v[16:31]
    ds_read_b128 v[108:111], v3 offset:7680
    v_exp_f32 v56, v56
    v_cvt_pk_bf16_f32 v82, v52, v53
    v_exp_f32 v57, v57
    v_exp_f32 v58, v58
    v_cvt_pk_bf16_f32 v83, v54, v55
    v_exp_f32 v59, v59
    v_exp_f32 v60, v60
    v_mfma_f32_32x32x16_bf16 v[32:47], v[96:99], v[80:83], v[32:47]
    ds_read_b128 v[88:91], v2 offset:8192
    v_cvt_pk_bf16_f32 v84, v56, v57
    v_exp_f32 v61, v61
    v_exp_f32 v62, v62
    v_cvt_pk_bf16_f32 v85, v58, v59
    buffer_load_dwordx4 v[192:195], v4, s[4:7], s28 offen
    s_add_u32 s28, s28, s29
    v_exp_f32 v63, v63
    v_exp_f32 v64, v64
    v_add_u32 v3, v5, v3
    v_cvt_pk_bf16_f32 v86, v60, v61
    v_exp_f32 v65, v65
    v_exp_f32 v66, v66
    v_cvt_pk_bf16_f32 v87, v62, v63
    v_exp_f32 v67, v67
    v_exp_f32 v68, v68
    v_mfma_f32_32x32x16_bf16 v[32:47], v[100:103], v[84:87], v[32:47]
    ds_read_b128 v[96:99], v3 offset:0
    buffer_load_dwordx4 v[196:199], v4, s[4:7], s30 offen
    s_add_u32 s30, s30, s39
    v_cvt_pk_bf16_f32 v80, v64, v65
    v_exp_f32 v69, v69
    v_exp_f32 v70, v70
    v_cvt_pk_bf16_f32 v81, v66, v67
    s_waitcnt lgkmcnt(1)
    v_exp_f32 v71, v71
    v_mfma_f32_32x32x16_bf16 v[48:63], v[88:91], v[8:11], v[16:31]
    ds_read_b128 v[100:103], v3 offset:512
    v_exp_f32 v72, v72
    v_cvt_pk_bf16_f32 v82, v68, v69
    v_exp_f32 v73, v73
    v_exp_f32 v74, v74
    v_cvt_pk_bf16_f32 v83, v70, v71
    v_exp_f32 v75, v75
    v_exp_f32 v76, v76
    v_mfma_f32_32x32x16_bf16 v[32:47], v[104:107], v[80:83], v[32:47]
    ds_read_b128 v[92:95], v2 offset:9216
    v_cvt_pk_bf16_f32 v84, v72, v73
    v_exp_f32 v77, v77
    v_add_u32 v2, 8192, v2
    v_exp_f32 v78, v78
    v_cvt_pk_bf16_f32 v85, v74, v75
    buffer_load_dwordx4 v[200:203], v4, s[4:7], s28 offen
    s_add_u32 s28, s28, s29
    s_add_u32 s11, s11, 1
    s_cmp_lt_u32 s11, 8
    v_exp_f32 v79, v79
    s_waitcnt vmcnt(0)
    s_barrier
k2_kernel_loop24:
    v_exp_f32 v48, v48
    s_setprio 1
    v_cvt_pk_bf16_f32 v86, v76, v77
    v_exp_f32 v49, v49
    v_exp_f32 v50, v50
    v_cvt_pk_bf16_f32 v87, v78, v79
    v_exp_f32 v51, v51
    v_exp_f32 v52, v52
    v_mfma_f32_32x32x16_bf16 v[32:47], v[108:111], v[84:87], v[32:47]
    ds_read_b128 v[104:107], v3 offset:1024
    buffer_load_dwordx4 v[204:207], v4, s[4:7], s30 offen
    s_add_u32 s30, s30, s39
    s_add_u32 s31, s58, 16384
    s_cmp_lt_u32 s11, 7
    s_cselect_b32 s30, s30, s31
    s_cselect_b32 s28, s28, s58
    s_cselect_b32 s29, s29, 0x8000
    s_cselect_b32 s39, s39, 0x8000
    v_cvt_pk_bf16_f32 v80, v48, v49
    v_exp_f32 v53, v53
    v_exp_f32 v54, v54
    v_cvt_pk_bf16_f32 v81, v50, v51
    s_waitcnt lgkmcnt(1)
    v_exp_f32 v55, v55
    v_mfma_f32_32x32x16_bf16 v[64:79], v[92:95], v[8:11], v[16:31]
    ds_read_b128 v[108:111], v3 offset:1536
    v_exp_f32 v56, v56
    v_cvt_pk_bf16_f32 v82, v52, v53
    v_exp_f32 v57, v57
    v_exp_f32 v58, v58
    v_cvt_pk_bf16_f32 v83, v54, v55
    v_exp_f32 v59, v59
    v_exp_f32 v60, v60
    v_mfma_f32_32x32x16_bf16 v[32:47], v[96:99], v[80:83], v[32:47]
    ds_read_b128 v[88:91], v2 offset:2048
    v_cvt_pk_bf16_f32 v84, v56, v57
    v_exp_f32 v61, v61
    v_exp_f32 v62, v62
    v_cvt_pk_bf16_f32 v85, v58, v59
    s_waitcnt vmcnt(14)
    v_mfma_f32_32x32x16_bf16 v[128:143], v[148:151], v[144:147], v[128:143]
    buffer_load_dwordx4 v[144:147], v4, s[4:7], s28 offen
    s_add_u32 s28, s28, s29
    v_exp_f32 v63, v63
    v_exp_f32 v64, v64
    v_cvt_pk_bf16_f32 v86, v60, v61
    v_exp_f32 v65, v65
    v_exp_f32 v66, v66
    v_cvt_pk_bf16_f32 v87, v62, v63
    v_exp_f32 v67, v67
    v_exp_f32 v68, v68
    v_mfma_f32_32x32x16_bf16 v[32:47], v[100:103], v[84:87], v[32:47]
    ds_read_b128 v[96:99], v3 offset:2048
    buffer_load_dwordx4 v[148:151], v4, s[4:7], s30 offen
    s_add_u32 s30, s30, s39
    v_cvt_pk_bf16_f32 v80, v64, v65
    v_exp_f32 v69, v69
    v_exp_f32 v70, v70
    v_cvt_pk_bf16_f32 v81, v66, v67
    s_waitcnt lgkmcnt(1)
    v_exp_f32 v71, v71
    v_mfma_f32_32x32x16_bf16 v[48:63], v[88:91], v[8:11], v[16:31]
    ds_read_b128 v[100:103], v3 offset:2560
    v_exp_f32 v72, v72
    v_cvt_pk_bf16_f32 v82, v68, v69
    v_exp_f32 v73, v73
    v_exp_f32 v74, v74
    v_cvt_pk_bf16_f32 v83, v70, v71
    v_exp_f32 v75, v75
    v_exp_f32 v76, v76
    v_mfma_f32_32x32x16_bf16 v[32:47], v[104:107], v[80:83], v[32:47]
    ds_read_b128 v[92:95], v2 offset:3072
    v_cvt_pk_bf16_f32 v84, v72, v73
    v_exp_f32 v77, v77
    v_exp_f32 v78, v78
    v_cvt_pk_bf16_f32 v85, v74, v75
    s_waitcnt vmcnt(14)
    v_mfma_f32_32x32x16_bf16 v[128:143], v[156:159], v[152:155], v[128:143]
    buffer_load_dwordx4 v[152:155], v4, s[4:7], s28 offen
    s_add_u32 s28, s28, s29
    v_exp_f32 v79, v79
    v_exp_f32 v48, v48
    v_cvt_pk_bf16_f32 v86, v76, v77
    v_exp_f32 v49, v49
    v_exp_f32 v50, v50
    v_cvt_pk_bf16_f32 v87, v78, v79
    v_exp_f32 v51, v51
    v_exp_f32 v52, v52
    v_mfma_f32_32x32x16_bf16 v[32:47], v[108:111], v[84:87], v[32:47]
    ds_read_b128 v[104:107], v3 offset:3072
    buffer_load_dwordx4 v[156:159], v4, s[4:7], s30 offen
    s_add_u32 s30, s30, s39
    v_cvt_pk_bf16_f32 v80, v48, v49
    v_exp_f32 v53, v53
    v_exp_f32 v54, v54
    v_cvt_pk_bf16_f32 v81, v50, v51
    s_waitcnt lgkmcnt(1)
    v_exp_f32 v55, v55
    v_mfma_f32_32x32x16_bf16 v[64:79], v[92:95], v[8:11], v[16:31]
    ds_read_b128 v[108:111], v3 offset:3584
    v_exp_f32 v56, v56
    v_cvt_pk_bf16_f32 v82, v52, v53
    v_exp_f32 v57, v57
    v_exp_f32 v58, v58
    v_cvt_pk_bf16_f32 v83, v54, v55
    v_exp_f32 v59, v59
    v_exp_f32 v60, v60
    v_mfma_f32_32x32x16_bf16 v[32:47], v[96:99], v[80:83], v[32:47]
    ds_read_b128 v[88:91], v2 offset:4096
    v_cvt_pk_bf16_f32 v84, v56, v57
    v_exp_f32 v61, v61
    v_exp_f32 v62, v62
    v_cvt_pk_bf16_f32 v85, v58, v59
    s_waitcnt vmcnt(14)
    v_mfma_f32_32x32x16_bf16 v[128:143], v[164:167], v[160:163], v[128:143]
    buffer_load_dwordx4 v[160:163], v4, s[4:7], s28 offen
    s_add_u32 s28, s28, s29
    v_exp_f32 v63, v63
    v_exp_f32 v64, v64
    v_cvt_pk_bf16_f32 v86, v60, v61
    v_exp_f32 v65, v65
    v_exp_f32 v66, v66
    v_cvt_pk_bf16_f32 v87, v62, v63
    v_exp_f32 v67, v67
    v_exp_f32 v68, v68
    v_mfma_f32_32x32x16_bf16 v[32:47], v[100:103], v[84:87], v[32:47]
    ds_read_b128 v[96:99], v3 offset:4096
    buffer_load_dwordx4 v[164:167], v4, s[4:7], s30 offen
    s_add_u32 s30, s30, s39
    v_cvt_pk_bf16_f32 v80, v64, v65
    v_exp_f32 v69, v69
    v_exp_f32 v70, v70
    v_cvt_pk_bf16_f32 v81, v66, v67
    s_waitcnt lgkmcnt(1)
    v_exp_f32 v71, v71
    v_mfma_f32_32x32x16_bf16 v[48:63], v[88:91], v[8:11], v[16:31]
    ds_read_b128 v[100:103], v3 offset:4608
    v_exp_f32 v72, v72
    v_cvt_pk_bf16_f32 v82, v68, v69
    v_exp_f32 v73, v73
    v_exp_f32 v74, v74
    v_cvt_pk_bf16_f32 v83, v70, v71
    v_exp_f32 v75, v75
    v_exp_f32 v76, v76
    v_mfma_f32_32x32x16_bf16 v[32:47], v[104:107], v[80:83], v[32:47]
    ds_read_b128 v[92:95], v2 offset:5120
    v_cvt_pk_bf16_f32 v84, v72, v73
    v_exp_f32 v77, v77
    v_exp_f32 v78, v78
    v_cvt_pk_bf16_f32 v85, v74, v75
    s_waitcnt vmcnt(14)
    v_mfma_f32_32x32x16_bf16 v[128:143], v[172:175], v[168:171], v[128:143]
    buffer_load_dwordx4 v[168:171], v4, s[4:7], s28 offen
    s_add_u32 s28, s28, s29
    v_exp_f32 v79, v79
    v_exp_f32 v48, v48
    v_cvt_pk_bf16_f32 v86, v76, v77
    v_exp_f32 v49, v49
    v_exp_f32 v50, v50
    v_cvt_pk_bf16_f32 v87, v78, v79
    v_exp_f32 v51, v51
    v_exp_f32 v52, v52
    v_mfma_f32_32x32x16_bf16 v[32:47], v[108:111], v[84:87], v[32:47]
    ds_read_b128 v[104:107], v3 offset:5120
    buffer_load_dwordx4 v[172:175], v4, s[4:7], s30 offen
    s_add_u32 s30, s30, s39
    v_cvt_pk_bf16_f32 v80, v48, v49
    v_exp_f32 v53, v53
    v_exp_f32 v54, v54
    v_cvt_pk_bf16_f32 v81, v50, v51
    s_waitcnt lgkmcnt(1)
    v_exp_f32 v55, v55
    v_mfma_f32_32x32x16_bf16 v[64:79], v[92:95], v[8:11], v[16:31]
    ds_read_b128 v[108:111], v3 offset:5632
    v_exp_f32 v56, v56
    v_cvt_pk_bf16_f32 v82, v52, v53
    v_exp_f32 v57, v57
    v_exp_f32 v58, v58
    v_cvt_pk_bf16_f32 v83, v54, v55
    v_exp_f32 v59, v59
    v_exp_f32 v60, v60
    v_mfma_f32_32x32x16_bf16 v[32:47], v[96:99], v[80:83], v[32:47]
    ds_read_b128 v[88:91], v2 offset:6144
    v_cvt_pk_bf16_f32 v84, v56, v57
    v_exp_f32 v61, v61
    v_exp_f32 v62, v62
    v_cvt_pk_bf16_f32 v85, v58, v59
    s_waitcnt vmcnt(14)
    v_mfma_f32_32x32x16_bf16 v[128:143], v[180:183], v[176:179], v[128:143]
    buffer_load_dwordx4 v[176:179], v4, s[4:7], s28 offen
    s_add_u32 s28, s28, s29
    v_exp_f32 v63, v63
    v_exp_f32 v64, v64
    v_cvt_pk_bf16_f32 v86, v60, v61
    v_exp_f32 v65, v65
    v_exp_f32 v66, v66
    v_cvt_pk_bf16_f32 v87, v62, v63
    v_exp_f32 v67, v67
    v_exp_f32 v68, v68
    v_mfma_f32_32x32x16_bf16 v[32:47], v[100:103], v[84:87], v[32:47]
    ds_read_b128 v[96:99], v3 offset:6144
    buffer_load_dwordx4 v[180:183], v4, s[4:7], s30 offen
    s_add_u32 s30, s30, s39
    v_cvt_pk_bf16_f32 v80, v64, v65
    v_exp_f32 v69, v69
    v_exp_f32 v70, v70
    v_cvt_pk_bf16_f32 v81, v66, v67
    s_waitcnt lgkmcnt(1)
    v_exp_f32 v71, v71
    v_mfma_f32_32x32x16_bf16 v[48:63], v[88:91], v[8:11], v[16:31]
    ds_read_b128 v[100:103], v3 offset:6656
    v_exp_f32 v72, v72
    v_cvt_pk_bf16_f32 v82, v68, v69
    v_exp_f32 v73, v73
    v_exp_f32 v74, v74
    v_cvt_pk_bf16_f32 v83, v70, v71
    v_exp_f32 v75, v75
    v_exp_f32 v76, v76
    v_mfma_f32_32x32x16_bf16 v[32:47], v[104:107], v[80:83], v[32:47]
    ds_read_b128 v[92:95], v2 offset:7168
    v_cvt_pk_bf16_f32 v84, v72, v73
    v_exp_f32 v77, v77
    v_exp_f32 v78, v78
    v_cvt_pk_bf16_f32 v85, v74, v75
    s_waitcnt vmcnt(14)
    v_mfma_f32_32x32x16_bf16 v[128:143], v[188:191], v[184:187], v[128:143]
    buffer_load_dwordx4 v[184:187], v4, s[4:7], s28 offen
    s_add_u32 s28, s28, s29
    v_exp_f32 v79, v79
    v_exp_f32 v48, v48
    s_setprio 0
    v_cvt_pk_bf16_f32 v86, v76, v77
    v_exp_f32 v49, v49
    v_exp_f32 v50, v50
    v_cvt_pk_bf16_f32 v87, v78, v79
    v_exp_f32 v51, v51
    v_exp_f32 v52, v52
    v_mfma_f32_32x32x16_bf16 v[32:47], v[108:111], v[84:87], v[32:47]
    ds_read_b128 v[104:107], v3 offset:7168
    buffer_load_dwordx4 v[188:191], v4, s[4:7], s30 offen
    s_add_u32 s30, s30, s39
    v_cvt_pk_bf16_f32 v80, v48, v49
    v_exp_f32 v53, v53
    v_exp_f32 v54, v54
    v_cvt_pk_bf16_f32 v81, v50, v51
    s_waitcnt lgkmcnt(1)
    v_exp_f32 v55, v55
    v_mfma_f32_32x32x16_bf16 v[64:79], v[92:95], v[8:11], v[16:31]
    ds_read_b128 v[108:111], v3 offset:7680
    v_exp_f32 v56, v56
    v_cvt_pk_bf16_f32 v82, v52, v53
    v_exp_f32 v57, v57
    v_exp_f32 v58, v58
    v_cvt_pk_bf16_f32 v83, v54, v55
    v_exp_f32 v59, v59
    v_exp_f32 v60, v60
    v_mfma_f32_32x32x16_bf16 v[32:47], v[96:99], v[80:83], v[32:47]
    ds_read_b128 v[88:91], v2 offset:8192
    v_cvt_pk_bf16_f32 v84, v56, v57
    v_exp_f32 v61, v61
    v_exp_f32 v62, v62
    v_cvt_pk_bf16_f32 v85, v58, v59
    s_waitcnt vmcnt(14)
    v_mfma_f32_32x32x16_bf16 v[128:143], v[196:199], v[192:195], v[128:143]
    buffer_load_dwordx4 v[192:195], v4, s[4:7], s28 offen
    s_add_u32 s28, s28, s29
    v_exp_f32 v63, v63
    v_exp_f32 v64, v64
    v_add_u32 v3, v5, v3
    v_cvt_pk_bf16_f32 v86, v60, v61
    v_exp_f32 v65, v65
    v_exp_f32 v66, v66
    v_cvt_pk_bf16_f32 v87, v62, v63
    v_exp_f32 v67, v67
    v_exp_f32 v68, v68
    v_mfma_f32_32x32x16_bf16 v[32:47], v[100:103], v[84:87], v[32:47]
    ds_read_b128 v[96:99], v3 offset:0
    buffer_load_dwordx4 v[196:199], v4, s[4:7], s30 offen
    s_add_u32 s30, s30, s39
    v_cvt_pk_bf16_f32 v80, v64, v65
    v_exp_f32 v69, v69
    v_exp_f32 v70, v70
    v_cvt_pk_bf16_f32 v81, v66, v67
    s_waitcnt lgkmcnt(1)
    v_exp_f32 v71, v71
    v_mfma_f32_32x32x16_bf16 v[48:63], v[88:91], v[8:11], v[16:31]
    ds_read_b128 v[100:103], v3 offset:512
    v_exp_f32 v72, v72
    v_cvt_pk_bf16_f32 v82, v68, v69
    v_exp_f32 v73, v73
    v_exp_f32 v74, v74
    v_cvt_pk_bf16_f32 v83, v70, v71
    v_exp_f32 v75, v75
    v_exp_f32 v76, v76
    v_mfma_f32_32x32x16_bf16 v[32:47], v[104:107], v[80:83], v[32:47]
    ds_read_b128 v[92:95], v2 offset:9216
    v_cvt_pk_bf16_f32 v84, v72, v73
    v_exp_f32 v77, v77
    v_add_u32 v2, 8192, v2
    v_exp_f32 v78, v78
    v_cvt_pk_bf16_f32 v85, v74, v75
    s_waitcnt vmcnt(14)
    v_mfma_f32_32x32x16_bf16 v[128:143], v[204:207], v[200:203], v[128:143]
    buffer_load_dwordx4 v[200:203], v4, s[4:7], s28 offen
    s_add_u32 s28, s28, s29
    s_add_u32 s11, s11, 1
    s_cmp_lt_u32 s11, 8
    v_exp_f32 v79, v79
    s_cbranch_scc1 k2_kernel_loop24
    s_setprio 0
k2_kernel_after5:
    s_nop 1
    v_cvt_pk_bf16_f32 v86, v76, v77
    v_cvt_pk_bf16_f32 v87, v78, v79
    s_nop 1
    v_mfma_f32_32x32x16_bf16 v[32:47], v[108:111], v[84:87], v[32:47]
    s_waitcnt lgkmcnt(0)
    s_nop 15
    v_mov_b32 v112, v40
    v_mov_b32 v113, v40
    s_nop 1
    v_permlane32_swap_b32 v112, v113
    s_nop 1
    s_cmp_eq_u32 s14, 1
    s_cbranch_scc1 k2_kernel_done7
    v_mov_b32 v114, 0x53800000
    v_cmp_nlt_f32 vcc, v112, v114
    v_mov_b32 v113, 0x207
    v_cmp_class_f32 s[26:27], v32, v113
    s_or_b64 vcc, vcc, s[26:27]
    v_cmp_class_f32 s[26:27], v33, v113
    s_or_b64 vcc, vcc, s[26:27]
    v_cmp_class_f32 s[26:27], v34, v113
    s_or_b64 vcc, vcc, s[26:27]
    v_cmp_class_f32 s[26:27], v35, v113
    s_or_b64 vcc, vcc, s[26:27]
    v_cmp_class_f32 s[26:27], v36, v113
    s_or_b64 vcc, vcc, s[26:27]
    v_cmp_class_f32 s[26:27], v37, v113
    s_or_b64 vcc, vcc, s[26:27]
    v_cmp_class_f32 s[26:27], v38, v113
    s_or_b64 vcc, vcc, s[26:27]
    v_cmp_class_f32 s[26:27], v39, v113
    s_or_b64 vcc, vcc, s[26:27]
    s_cmp_eq_u64 vcc, 0
    s_cbranch_scc1 k2_kernel_done7
    s_mov_b32 s14, 1
    v_mov_b32 v2, v4
    v_mov_b32 v112, 0xff800000
    s_mov_b32 s11, 0
k2_kernel_fbloop8:
    ds_read_b128 v[88:91], v2
    s_waitcnt lgkmcnt(0)
    v_mfma_f32_32x32x16_bf16 v[48:63], v[88:91], v[8:11], 0
    s_nop 15
    v_max3_f32 v112, v112, v48, v49
    v_max3_f32 v112, v112, v50, v51
    v_max3_f32 v112, v112, v52, v53
    v_max3_f32 v112, v112, v54, v55
    v_max3_f32 v112, v112, v56, v57
    v_max3_f32 v112, v112, v58, v59
    v_max3_f32 v112, v112, v60, v61
    v_max3_f32 v112, v112, v62, v63
    v_add_u32 v2, 0x400, v2
    s_add_u32 s11, s11, 1
    s_cmp_lt_u32 s11, 64
    s_cbranch_scc1 k2_kernel_fbloop8
    s_waitcnt vmcnt(0)
    v_mov_b32 v144, 0
    v_mov_b32 v145, 0
    v_mov_b32 v146, 0
    v_mov_b32 v147, 0
    v_mov_b32 v148, 0
    v_mov_b32 v149, 0
    v_mov_b32 v150, 0
    v_mov_b32 v151, 0
    v_mov_b32 v152, 0
    v_mov_b32 v153, 0
    v_mov_b32 v154, 0
    v_mov_b32 v155, 0
    v_mov_b32 v156, 0
    v_mov_b32 v157, 0
    v_mov_b32 v158, 0
    v_mov_b32 v159, 0
    v_mov_b32 v160, 0
    v_mov_b32 v161, 0
    v_mov_b32 v162, 0
    v_mov_b32 v163, 0
    v_mov_b32 v164, 0
    v_mov_b32 v165, 0
    v_mov_b32 v166, 0
    v_mov_b32 v167, 0
    v_mov_b32 v168, 0
    v_mov_b32 v169, 0
    v_mov_b32 v170, 0
    v_mov_b32 v171, 0
    v_mov_b32 v172, 0
    v_mov_b32 v173, 0
    v_mov_b32 v174, 0
    v_mov_b32 v175, 0
    v_mov_b32 v176, 0
    v_mov_b32 v177, 0
    v_mov_b32 v178, 0
    v_mov_b32 v179, 0
    v_mov_b32 v180, 0
    v_mov_b32 v181, 0
    v_mov_b32 v182, 0
    v_mov_b32 v183, 0
    v_mov_b32 v184, 0
    v_mov_b32 v185, 0
    v_mov_b32 v186, 0
    v_mov_b32 v187, 0
    v_mov_b32 v188, 0
    v_mov_b32 v189, 0
    v_mov_b32 v190, 0
    v_mov_b32 v191, 0
    v_mov_b32 v192, 0
    v_mov_b32 v193, 0
    v_mov_b32 v194, 0
    v_mov_b32 v195, 0
    v_mov_b32 v196, 0
    v_mov_b32 v197, 0
    v_mov_b32 v198, 0
    v_mov_b32 v199, 0
    v_mov_b32 v200, 0
    v_mov_b32 v201, 0
    v_mov_b32 v202, 0
    v_mov_b32 v203, 0
    v_mov_b32 v204, 0
    v_mov_b32 v205, 0
    v_mov_b32 v206, 0
    v_mov_b32 v207, 0
    s_branch k2_kernel_restart1
k2_kernel_done7:
    v_rcp_f32 v112, v112
    s_nop 0
    v_mul_f32 v32, v32, v112
    v_mul_f32 v33, v33, v112
    v_mul_f32 v34, v34, v112
    v_mul_f32 v35, v35, v112
    v_mul_f32 v36, v36, v112
    v_mul_f32 v37, v37, v112
    v_mul_f32 v38, v38, v112
    v_mul_f32 v39, v39, v112
    v_cvt_pk_bf16_f32 v116, v32, v33
    v_cvt_pk_bf16_f32 v117, v34, v35
    v_cvt_pk_bf16_f32 v118, v36, v37
    v_cvt_pk_bf16_f32 v119, v38, v39
    s_mul_i32 s12, s10, 144
    s_add_u32 s12, s12, s9
    s_lshl_b32 s12, s12, 10
    s_add_u32 s12, s12, 0x600000
    buffer_store_dwordx4 v[116:119], v4, s[4:7], s12 offen sc0 sc1
    s_load_dwordx2 s[54:55], s[0:1], 0
    s_load_dwordx2 s[56:57], s[0:1], 56
    s_load_dwordx2 s[48:49], s[0:1], 64
    s_and_b32 s50, s8, 1
    s_bfe_u32 s51, s8, 0x10001
    s_lshr_b32 s52, s8, 2
    buffer_load_dwordx4 v[204:207], v4, s[4:7], s30 offen
    v_and_b32 v120, 31, v1
    v_lshlrev_b32 v120, 10, v120
    v_lshrrev_b32 v121, 5, v1
    v_lshl_add_u32 v120, v121, 3, v120
    s_lshl_b32 s53, s34, 1
    s_add_u32 s53, s53, s51
    s_lshl_b32 s53, s53, 15
    s_lshl_b32 s32, s35, 7
    s_add_u32 s53, s53, s32
    s_lshl_b32 s32, s50, 6
    s_add_u32 s53, s53, s32
    s_lshl_b32 s32, s52, 5
    s_add_u32 s53, s53, s32
    s_waitcnt lgkmcnt(0)
    s_mov_b32 s40, s54
    s_and_b32 s41, s55, 0xffff
    s_mov_b32 s42, 0x200000
    s_mov_b32 s43, 0x20000
    s_mov_b32 s44, s56
    s_and_b32 s45, s57, 0xffff
    s_mov_b32 s46, 0x200000
    s_mov_b32 s47, 0x20000
    buffer_load_dwordx2 v[80:81], v120, s[40:43], s53 offen
    buffer_load_dwordx2 v[82:83], v120, s[40:43], s53 offen offset:16
    s_waitcnt vmcnt(3)
    s_barrier
    s_cmp_lg_u32 s8, 0
    s_cbranch_scc1 k2_kernel_notw09
    s_lshr_b32 s31, s2, 5
    s_lshl_b32 s31, s31, 10
    s_add_u32 s31, s31, 0x1180000
    v_lshlrev_b32 v112, 8, v1
    v_mov_b32 v113, 1
    s_mov_b64 exec, 15
    buffer_atomic_add v113, v112, s[4:7], s31 offen sc1
    s_mov_b64 exec, 1
    s_lshl_b32 s31, s34, 8
    s_add_u32 s31, s31, 0x1180000
    v_mov_b32 v112, 0
    s_mov_b32 s32, 0
k2_kernel_poll10:
    buffer_load_dword v113, v112, s[4:7], s31 offen sc1
    s_waitcnt vmcnt(0)
    v_readfirstlane_b32 s33, v113
    s_add_u32 s32, s32, 1
    s_cmp_ge_u32 s33, 32
    s_cbranch_scc1 k2_kernel_polldone11
    s_cmp_lt_u32 s32, 65536
    s_sleep 4
    s_cbranch_scc1 k2_kernel_poll10
k2_kernel_polldone11:
    s_mov_b64 exec, -1
k2_kernel_notw09:
    s_barrier
    s_lshl_b32 s31, s34, 1
    s_add_u32 s31, s31, s51
    s_mul_i32 s31, s31, 144
    s_lshl_b32 s32, s52, 4
    s_add_u32 s31, s31, s32
    s_lshl_b32 s31, s31, 10
    s_add_u32 s31, s31, 0x600000
    buffer_load_dwordx4 v[16:19], v4, s[4:7], s31 offen offset:0 sc1
    buffer_load_dwordx4 v[20:23], v4, s[4:7], s31 offen offset:1024 sc1
    buffer_load_dwordx4 v[24:27], v4, s[4:7], s31 offen offset:2048 sc1
    buffer_load_dwordx4 v[28:31], v4, s[4:7], s31 offen offset:3072 sc1
    s_add_u32 s31, s31, 4096
    buffer_load_dwordx4 v[32:35], v4, s[4:7], s31 offen offset:0 sc1
    buffer_load_dwordx4 v[36:39], v4, s[4:7], s31 offen offset:1024 sc1
    buffer_load_dwordx4 v[40:43], v4, s[4:7], s31 offen offset:2048 sc1
    buffer_load_dwordx4 v[44:47], v4, s[4:7], s31 offen offset:3072 sc1
    s_add_u32 s31, s31, 4096
    buffer_load_dwordx4 v[48:51], v4, s[4:7], s31 offen offset:0 sc1
    buffer_load_dwordx4 v[52:55], v4, s[4:7], s31 offen offset:1024 sc1
    buffer_load_dwordx4 v[56:59], v4, s[4:7], s31 offen offset:2048 sc1
    buffer_load_dwordx4 v[60:63], v4, s[4:7], s31 offen offset:3072 sc1
    s_add_u32 s31, s31, 4096
    buffer_load_dwordx4 v[64:67], v4, s[4:7], s31 offen offset:0 sc1
    buffer_load_dwordx4 v[68:71], v4, s[4:7], s31 offen offset:1024 sc1
    buffer_load_dwordx4 v[72:75], v4, s[4:7], s31 offen offset:2048 sc1
    buffer_load_dwordx4 v[76:79], v4, s[4:7], s31 offen offset:3072 sc1
    s_waitcnt vmcnt(15)
    v_mfma_f32_32x32x16_bf16 v[128:143], v[144:147], v[16:19], v[128:143]
    s_waitcnt vmcnt(14)
    v_mfma_f32_32x32x16_bf16 v[128:143], v[148:151], v[20:23], v[128:143]
    s_waitcnt vmcnt(13)
    v_mfma_f32_32x32x16_bf16 v[128:143], v[152:155], v[24:27], v[128:143]
    s_waitcnt vmcnt(12)
    v_mfma_f32_32x32x16_bf16 v[128:143], v[156:159], v[28:31], v[128:143]
    s_waitcnt vmcnt(11)
    v_mfma_f32_32x32x16_bf16 v[128:143], v[160:163], v[32:35], v[128:143]
    s_waitcnt vmcnt(10)
    v_mfma_f32_32x32x16_bf16 v[128:143], v[164:167], v[36:39], v[128:143]
    s_waitcnt vmcnt(9)
    v_mfma_f32_32x32x16_bf16 v[128:143], v[168:171], v[40:43], v[128:143]
    s_waitcnt vmcnt(8)
    v_mfma_f32_32x32x16_bf16 v[128:143], v[172:175], v[44:47], v[128:143]
    s_waitcnt vmcnt(7)
    v_mfma_f32_32x32x16_bf16 v[128:143], v[176:179], v[48:51], v[128:143]
    s_waitcnt vmcnt(6)
    v_mfma_f32_32x32x16_bf16 v[128:143], v[180:183], v[52:55], v[128:143]
    s_waitcnt vmcnt(5)
    v_mfma_f32_32x32x16_bf16 v[128:143], v[184:187], v[56:59], v[128:143]
    s_waitcnt vmcnt(4)
    v_mfma_f32_32x32x16_bf16 v[128:143], v[188:191], v[60:63], v[128:143]
    s_waitcnt vmcnt(3)
    v_mfma_f32_32x32x16_bf16 v[128:143], v[192:195], v[64:67], v[128:143]
    s_waitcnt vmcnt(2)
    v_mfma_f32_32x32x16_bf16 v[128:143], v[196:199], v[68:71], v[128:143]
    s_waitcnt vmcnt(1)
    v_mfma_f32_32x32x16_bf16 v[128:143], v[200:203], v[72:75], v[128:143]
    s_waitcnt vmcnt(0)
    v_mfma_f32_32x32x16_bf16 v[128:143], v[204:207], v[76:79], v[128:143]
    s_nop 15
    s_and_b32 s31, s8, 3
    s_lshl_b32 s31, s31, 12
    s_add_u32 s31, s31, 139520
    v_add_u32 v112, s31, v4
    s_cmp_eq_u32 s52, 0
    s_cbranch_scc1 k2_kernel_lo12
    ds_write_b128 v112, v[128:131]
    ds_write_b128 v112, v[132:135] offset:1024
    s_waitcnt lgkmcnt(0)
    s_barrier
    ds_read_b128 v[144:147], v112 offset:2048
    ds_read_b128 v[148:151], v112 offset:3072
    v_mov_b32 v152, v136
    v_mov_b32 v153, v137
    v_mov_b32 v154, v138
    v_mov_b32 v155, v139
    v_mov_b32 v156, v140
    v_mov_b32 v157, v141
    v_mov_b32 v158, v142
    v_mov_b32 v159, v143
    s_branch k2_kernel_j13
k2_kernel_lo12:
    ds_write_b128 v112, v[136:139] offset:2048
    ds_write_b128 v112, v[140:143] offset:3072
    s_waitcnt lgkmcnt(0)
    s_barrier
    ds_read_b128 v[144:147], v112
    ds_read_b128 v[148:151], v112 offset:1024
    v_mov_b32 v152, v128
    v_mov_b32 v153, v129
    v_mov_b32 v154, v130
    v_mov_b32 v155, v131
    v_mov_b32 v156, v132
    v_mov_b32 v157, v133
    v_mov_b32 v158, v134
    v_mov_b32 v159, v135
k2_kernel_j13:
    v_lshlrev_b32 v160, 16, v80
    v_and_b32 v161, 0xffff0000, v80
    v_lshlrev_b32 v162, 16, v81
    v_and_b32 v163, 0xffff0000, v81
    v_lshlrev_b32 v164, 16, v82
    v_and_b32 v165, 0xffff0000, v82
    v_lshlrev_b32 v166, 16, v83
    v_and_b32 v167, 0xffff0000, v83
    v_add_f32 v152, v152, v160
    v_add_f32 v153, v153, v161
    v_add_f32 v154, v154, v162
    v_add_f32 v155, v155, v163
    v_add_f32 v156, v156, v164
    v_add_f32 v157, v157, v165
    v_add_f32 v158, v158, v166
    v_add_f32 v159, v159, v167
    s_waitcnt lgkmcnt(0)
    v_add_f32 v152, v152, v144
    v_add_f32 v153, v153, v145
    v_add_f32 v154, v154, v146
    v_add_f32 v155, v155, v147
    v_add_f32 v156, v156, v148
    v_add_f32 v157, v157, v149
    v_add_f32 v158, v158, v150
    v_add_f32 v159, v159, v151
    v_cvt_pk_bf16_f32 v168, v152, v153
    v_cvt_pk_bf16_f32 v169, v154, v155
    v_cvt_pk_bf16_f32 v170, v156, v157
    v_cvt_pk_bf16_f32 v171, v158, v159
    buffer_store_dwordx2 v[168:169], v120, s[44:47], s53 offen
    buffer_store_dwordx2 v[170:171], v120, s[44:47], s53 offen offset:16
k2_end:
    s_endpgm
.section .rodata,"a"
.p2align 6
.amdhsa_kernel k1_kernel
  .amdhsa_next_free_vgpr 168
  .amdhsa_next_free_sgpr 80
  .amdhsa_accum_offset 168
  .amdhsa_group_segment_fixed_size 0
  .amdhsa_kernarg_size 80
  .amdhsa_user_sgpr_count 2
  .amdhsa_user_sgpr_kernarg_segment_ptr 1
  .amdhsa_system_sgpr_workgroup_id_x 1
.end_amdhsa_kernel
.section .rodata,"a"
.p2align 6
.amdhsa_kernel k2_kernel
  .amdhsa_next_free_vgpr 208
  .amdhsa_next_free_sgpr 64
  .amdhsa_accum_offset 208
  .amdhsa_group_segment_fixed_size 0
  .amdhsa_kernarg_size 80
  .amdhsa_user_sgpr_count 2
  .amdhsa_user_sgpr_kernarg_segment_ptr 1
  .amdhsa_system_sgpr_workgroup_id_x 1
.end_amdhsa_kernel
```
